```python
import torch

def _softmax(x, axis=-1):
    return torch.softmax(x, dim=axis)
def _gelu(x):
    return torch.nn.functional.gelu(x, approximate="tanh")
def _silu(x):
    return torch.nn.functional.silu(x)
def _sigmoid(x):
    return torch.sigmoid(x)
def _layernorm(x, axis=-1, eps=1e-5):
    m = x.mean(dim=axis, keepdim=True)
    v = x.var(dim=axis, keepdim=True, unbiased=False)
    return (x - m) / torch.sqrt(v + eps)
def _scatter_add(tgt, idx, src, axis=0):
    return tgt.clone().index_add_(axis, idx, src)
def _segment_sum(src, seg, n):
    out = torch.zeros((n,) + src.shape[1:], dtype=src.dtype)
    return out.index_add_(0, seg, src)
def _pad(x, pw):
    flat = tuple(v for pair in reversed(pw) for v in pair)
    return torch.nn.functional.pad(x, flat)

kernel_name = 'parallel_sum__linear_kernel_hedgehog__mixer_channel_mlp__prompt'

def setup_inputs():

    _w = (lambda a: (lambda t: t.to(torch.bfloat16) if t.is_floating_point() else t)(torch.as_tensor(a)))
    def _A_setup():
        B, S, D, H = 1, 2048, 512, 32
        Dh = D // H
        return {
            "x": _w((lambda *s: torch.randn(*s, dtype=torch.bfloat16) * 0.05)(B, S, D)),
            "wqkv": _w((lambda *s: torch.randn(*s, dtype=torch.bfloat16) * 0.2)(D, 3 * D)),
            "w_phi": _w((lambda *s: torch.randn(*s, dtype=torch.bfloat16) * 0.2)(H, Dh, Dh) * (Dh ** -0.5)),
            "wo": _w((lambda *s: torch.randn(*s, dtype=torch.bfloat16) * 0.05)(D, D)),
        }
    _A_in = _A_setup()

    def _B_setup():
        B, S, D, F = 1, 2048, 512, 1376
        return {
            "x": _w((lambda *s: torch.randn(*s, dtype=torch.bfloat16) * 0.05)(B, S, D)),
            "w1": _w((lambda *s: torch.randn(*s, dtype=torch.bfloat16) * 1.6)(D, F) * (D ** -0.5)),
            "b1": _w((lambda *s: torch.randn(*s, dtype=torch.bfloat16) * 1.6)(F)),
            "w2": _w((lambda *s: torch.randn(*s, dtype=torch.bfloat16) * 0.05)(F, D) * (F ** -0.5)),
            "b2": _w((lambda *s: torch.randn(*s, dtype=torch.bfloat16) * 0.05)(D)),
        }
    _B_in = _B_setup()

    return {
        "A_x": _A_in["x"],
        "A_wqkv": _A_in["wqkv"],
        "A_w_phi": _A_in["w_phi"],
        "A_wo": _A_in["wo"],
        "B_x": _B_in["x"],
        "B_w1": _B_in["w1"],
        "B_b1": _B_in["b1"],
        "B_w2": _B_in["w2"],
        "B_b2": _B_in["b2"],
    }

def reference(A_x, A_wqkv, A_w_phi, A_wo, B_x, B_w1, B_b1, B_w2, B_b2):
    def _A_ref(x, wqkv, w_phi, wo):
        B, S, D = x.shape
        H = 32; Dh = D // H
        qkv = (lambda x, *d: x.permute(*d))((x @ wqkv).reshape(B, S, 3, H, Dh), 2, 0, 3, 1, 4)
        q, k, v = qkv[0], qkv[1], qkv[2]
        pq = torch.einsum("bhsd,hdf->bhsf", q, w_phi)
        pk = torch.einsum("bhsd,hdf->bhsf", k, w_phi)
        phi_q = torch.concatenate([_softmax(pq, axis=-1), _softmax(-pq, axis=-1)], axis=-1)
        phi_k = torch.concatenate([_softmax(pk, axis=-1), _softmax(-pk, axis=-1)], axis=-1)
        kv = torch.einsum("bhsf,bhsd->bhfd", phi_k, v)
        z  = torch.einsum("bhsf->bhf", phi_k)
        num = torch.einsum("bhqf,bhfd->bhqd", phi_q, kv)
        den = torch.einsum("bhqf,bhf->bhq", phi_q, z)[..., None] + 1e-6
        o = num / den
        return (lambda x, *d: x.permute(*d))(o, 0, 2, 1, 3).reshape(B, S, D) @ wo

    def _B_ref(x, w1, b1, w2, b2):
        y = _layernorm(x, axis=-1)
        h = _gelu(torch.einsum("bsd,df->bsf", y, w1) + b1)
        return torch.einsum("bsf,fd->bsd", h, w2) + b2

    x = A_x
    xn = _layernorm(x, axis=-1)
    return x + _A_ref(xn, A_wqkv, A_w_phi, A_wo) + _B_ref(xn, B_w1, B_b1, B_w2, B_b2)
```

```asm
; @launch kernel=k1_kernel grid=(256,1,1) block=(512,1,1) lds=163840
; @launch kernel=k2_kernel grid=(256,1,1) block=(256,1,1) lds=114688
.amdgcn_target "amdgcn-amd-amdhsa--gfx950"
.text
.globl k1_kernel
.p2align 8
.type k1_kernel,@function
k1_kernel:
    s_cmp_ge_u32 s2, 256
    s_cbranch_scc1 K1_END
    s_load_dwordx4 s[32:35], s[0:1], 0
    s_load_dwordx2 s[36:37], s[0:1], 16
    s_load_dwordx4 s[40:43], s[0:1], 40
    s_load_dwordx2 s[44:45], s[0:1], 88
    s_load_dwordx2 s[88:89], s[0:1], 24
    s_load_dwordx2 s[90:91], s[0:1], 56
    s_load_dwordx2 s[62:63], s[0:1], 72
    v_lshrrev_b32 v20, 6, v0
    v_and_b32 v1, 63, v0
    v_readfirstlane_b32 s22, v20
    s_and_b32 s31, s2, 7
    s_lshr_b32 s38, s2, 3
    s_and_b32 s20, s31, 1
    s_lshl_b32 s20, s20, 3
    s_bfe_u32 s39, s38, 0x30001
    s_add_u32 s20, s20, s39
    s_lshr_b32 s21, s31, 1
    s_and_b32 s39, s38, 1
    s_lshl_b32 s39, s39, 2
    s_add_u32 s21, s21, s39
    s_lshr_b32 s39, s38, 4
    s_lshl_b32 s39, s39, 3
    s_add_u32 s21, s21, s39
    s_and_b32 s23, s22, 3
    s_lshr_b32 s24, s22, 2
    s_xor_b32 s46, s23, s24
    v_lshrrev_b32 v20, 3, v1
    v_lshrrev_b32 v21, 4, v1
    v_and_b32 v22, 7, v1
    s_lshl_b32 s39, s20, 7
    s_lshl_b32 s47, s22, 4
    s_add_u32 s39, s39, s47
    v_add_u32 v23, s39, v20
    v_lshlrev_b32 v23, 10, v23
    v_xor_b32 v24, v22, v21
    v_lshl_add_u32 v2, v24, 4, v23
    v_xor_b32 v24, 4, v24
    v_lshl_add_u32 v3, v24, 4, v23
    v_add_u32 v3, 0x2000, v3
    v_and_b32 v24, 1, v21
    v_lshlrev_b32 v24, 2, v24
    v_xor_b32 v24, v22, v24
    v_lshlrev_b32 v24, 4, v24
    s_lshl_b32 s47, s22, 3
    v_add_u32 v25, s47, v20
    v_lshrrev_b32 v26, 5, v1
    v_and_b32 v27, 31, v1
    s_sub_u32 s49, s21, 8
    s_mul_i32 s28, s49, 384
    s_lshl_b32 s47, s21, 7
    s_movk_i32 s48, 3072
    s_movk_i32 s29, 1024
    s_cmp_ge_u32 s21, 8
    s_cselect_b32 s28, s28, s47
    s_cselect_b32 s48, 2752, s48
    s_cselect_b32 s29, 128, s29
    v_mul_lo_u32 v4, s48, v25
    v_add_u32 v4, v4, v24
    s_lshl_b32 s30, s48, 6
    s_mov_b32 s27, 0
    s_lshl_b32 s10, s48, 9
    s_mov_b32 s11, 0x20000
    s_mov_b32 s6, 2048*1024
    s_mov_b32 s7, 0x20000
    s_lshl_b32 s50, s22, 11
    s_lshl_b32 s51, s22, 10
    s_add_u32 s51, s51, 16384
    s_mov_b32 s26, 0
    s_cmp_ge_u32 s21, 8
    s_waitcnt lgkmcnt(0)
    s_mov_b32 s4, s32
    s_mov_b32 s5, s33
    s_cselect_b32 s8, s40, s34
    s_cselect_b32 s9, s41, s35
    s_add_u32 m0, s26, s50
    s_add_u32 s53, s28, s29
    buffer_load_dwordx4 v2, s[4:7], s27 offen lds
    s_add_u32 m0, m0, 1024
    s_add_u32 s54, s53, s29
    buffer_load_dwordx4 v3, s[4:7], s27 offen lds
    s_add_u32 m0, s26, s51
    s_add_u32 s27, s27, 128
    buffer_load_dwordx4 v4, s[8:11], s28 offen lds
    s_add_u32 m0, m0, 8192
    s_add_u32 s28, s28, s30
    buffer_load_dwordx4 v4, s[8:11], s53 offen lds
    s_add_u32 m0, m0, 8192
    s_add_u32 s26, s26, 40960
    buffer_load_dwordx4 v4, s[8:11], s54 offen lds
    s_mov_b32 s12, s44
    s_mov_b32 s13, s45
    s_mov_b32 s14, 50331648
    s_mov_b32 s15, 0x20000
    s_cmp_ge_u32 s21, 8
    s_cbranch_scc1 K1_HSET
    s_mov_b32 s16, s36
    s_mov_b32 s17, s37
    s_mov_b32 s18, 16384
    s_mov_b32 s19, 0x20000
    s_lshl_b32 s47, s21, 2
    s_lshl_b32 s53, s24, 1
    s_add_u32 s56, s47, s53
    s_lshl_b32 s47, s56, 9
    v_lshlrev_b32 v20, 4, v1
    s_add_u32 m0, s51, 122880-16384
    s_nop 0
    buffer_load_dwordx4 v20, s[16:19], s47 offen lds
    s_branch K1_SET
K1_HSET:
    s_mov_b32 s16, s42
    s_mov_b32 s17, s43
    s_mov_b32 s18, 2752
    s_mov_b32 s19, 0x20000
    s_mul_i32 s47, s49, 384
    s_lshl_b32 s53, s24, 6
    s_add_u32 s47, s47, s53
    v_lshlrev_b32 v20, 1, v27
    buffer_load_ushort v28, v20, s[16:19], s47 offen offset:0
    buffer_load_ushort v29, v20, s[16:19], s47 offen offset:128
    buffer_load_ushort v30, v20, s[16:19], s47 offen offset:256
    s_lshr_b32 s47, s2, 3
    s_cmp_lg_u32 s47, 16
    s_cbranch_scc1 K1_SET
    s_and_b32 s47, s2, 7
    s_lshl_b32 s47, s47, 13
    s_add_u32 s47, s47, 12582912
    v_lshlrev_b32 v20, 4, v0
    v_mov_b32 v64, -1
    v_mov_b32 v65, -1
    v_mov_b32 v66, -1
    v_mov_b32 v67, -1
    buffer_store_dwordx4 v[64:67], v20, s[12:15], s47 offen sc1
s_waitcnt vmcnt(0)
K1_SET:
    s_add_u32 m0, s26, s50
    s_add_u32 s53, s28, s29
    buffer_load_dwordx4 v2, s[4:7], s27 offen lds
    s_add_u32 m0, m0, 1024
    s_add_u32 s54, s53, s29
    buffer_load_dwordx4 v3, s[4:7], s27 offen lds
    s_add_u32 m0, s26, s51
    s_add_u32 s27, s27, 128
    buffer_load_dwordx4 v4, s[8:11], s28 offen lds
    s_add_u32 m0, m0, 8192
    s_add_u32 s28, s28, s30
    buffer_load_dwordx4 v4, s[8:11], s53 offen lds
    s_add_u32 m0, m0, 8192
    s_add_u32 s26, s26, 40960
    buffer_load_dwordx4 v4, s[8:11], s54 offen lds
    s_lshl_b32 s47, s23, 5
    v_add_u32 v20, s47, v27
    v_bfe_u32 v21, v20, 1, 3
    v_xor_b32 v21, v21, v26
    v_lshlrev_b32 v20, 7, v20
    s_xor_b32 s47, s46, 0
    s_lshl_b32 s47, s47, 1
    v_xor_b32 v22, s47, v21
    v_lshl_add_u32 v5, v22, 4, v20
    s_xor_b32 s47, s46, 1
    s_lshl_b32 s47, s47, 1
    v_xor_b32 v22, s47, v21
    v_lshl_add_u32 v6, v22, 4, v20
    s_xor_b32 s47, s46, 2
    s_lshl_b32 s47, s47, 1
    v_xor_b32 v22, s47, v21
    v_lshl_add_u32 v7, v22, 4, v20
    s_xor_b32 s47, s46, 3
    s_lshl_b32 s47, s47, 1
    v_xor_b32 v22, s47, v21
    v_lshl_add_u32 v8, v22, 4, v20
    v_bfe_u32 v20, v1, 2, 2
    v_lshl_add_u32 v20, v26, 3, v20
    v_lshlrev_b32 v20, 7, v20
    v_bfe_u32 v21, v1, 4, 1
    v_bfe_u32 v22, v1, 1, 1
    v_lshl_add_u32 v21, v21, 1, v22
    v_bfe_u32 v22, v1, 3, 1
    v_xor_b32 v22, s24, v22
    v_lshl_add_u32 v21, v22, 2, v21
    v_lshl_add_u32 v20, v21, 4, v20
    v_and_b32 v22, 1, v1
    v_lshl_add_u32 v20, v22, 3, v20
    s_xor_b32 s47, s46, 0
    s_lshl_b32 s47, s47, 11
    s_add_u32 s47, s47, 16384
    v_add_u32 v36, s47, v20
    s_xor_b32 s47, s46, 1
    s_lshl_b32 s47, s47, 11
    s_add_u32 s47, s47, 16384
    v_add_u32 v37, s47, v20
    s_xor_b32 s47, s46, 2
    s_lshl_b32 s47, s47, 11
    s_add_u32 s47, s47, 16384
    v_add_u32 v38, s47, v20
    s_xor_b32 s47, s46, 3
    s_lshl_b32 s47, s47, 11
    s_add_u32 s47, s47, 16384
    v_add_u32 v39, s47, v20
    v_mov_b32 v12, 0
    v_mov_b32 v13, 0
    v_mov_b32 v64, 0
    v_mov_b32 v65, 0
    v_mov_b32 v66, 0
    v_mov_b32 v67, 0
    v_mov_b32 v68, 0
    v_mov_b32 v69, 0
    v_mov_b32 v70, 0
    v_mov_b32 v71, 0
    v_mov_b32 v72, 0
    v_mov_b32 v73, 0
    v_mov_b32 v74, 0
    v_mov_b32 v75, 0
    v_mov_b32 v76, 0
    v_mov_b32 v77, 0
    v_mov_b32 v78, 0
    v_mov_b32 v79, 0
    v_mov_b32 v80, 0
    v_mov_b32 v81, 0
    v_mov_b32 v82, 0
    v_mov_b32 v83, 0
    v_mov_b32 v84, 0
    v_mov_b32 v85, 0
    v_mov_b32 v86, 0
    v_mov_b32 v87, 0
    v_mov_b32 v88, 0
    v_mov_b32 v89, 0
    v_mov_b32 v90, 0
    v_mov_b32 v91, 0
    v_mov_b32 v92, 0
    v_mov_b32 v93, 0
    v_mov_b32 v94, 0
    v_mov_b32 v95, 0
    v_mov_b32 v96, 0
    v_mov_b32 v97, 0
    v_mov_b32 v98, 0
    v_mov_b32 v99, 0
    v_mov_b32 v100, 0
    v_mov_b32 v101, 0
    v_mov_b32 v102, 0
    v_mov_b32 v103, 0
    v_mov_b32 v104, 0
    v_mov_b32 v105, 0
    v_mov_b32 v106, 0
    v_mov_b32 v107, 0
    v_mov_b32 v108, 0
    v_mov_b32 v109, 0
    v_mov_b32 v110, 0
    v_mov_b32 v111, 0
    v_mov_b32 v128, 0
    v_mov_b32 v129, 0
    v_mov_b32 v130, 0
    v_mov_b32 v131, 0
    v_mov_b32 v132, 0
    v_mov_b32 v133, 0
    v_mov_b32 v134, 0
    v_mov_b32 v135, 0
    v_mov_b32 v136, 0
    v_mov_b32 v137, 0
    v_mov_b32 v138, 0
    v_mov_b32 v139, 0
    v_mov_b32 v140, 0
    v_mov_b32 v141, 0
    v_mov_b32 v142, 0
    v_mov_b32 v143, 0
    v_mov_b32 v144, 0
    v_mov_b32 v145, 0
    v_mov_b32 v146, 0
    v_mov_b32 v147, 0
    v_mov_b32 v148, 0
    v_mov_b32 v149, 0
    v_mov_b32 v150, 0
    v_mov_b32 v151, 0
    v_mov_b32 v152, 0
    v_mov_b32 v153, 0
    v_mov_b32 v154, 0
    v_mov_b32 v155, 0
    v_mov_b32 v156, 0
    v_mov_b32 v157, 0
    v_mov_b32 v158, 0
    v_mov_b32 v159, 0
    s_mov_b32 s25, 0
    s_mov_b32 s55, 0xffff0000
    s_mov_b32 s59, -81920
    s_mov_b32 s60, 0
    s_mov_b32 s52, 0x400000
    s_mov_b32 s61, 1376*1024
    v_bfe_u32 v20, v1, 2, 2
    v_bfe_u32 v21, v1, 4, 1
    v_cmp_eq_u32 vcc, v20, v21
    v_mov_b32 v20, 0x3f803f80
    s_nop 0
    v_cndmask_b32 v160, 0, v20, vcc
    v_mov_b32 v161, v160
    v_mov_b32 v162, v160
    v_mov_b32 v163, v160
    s_cmp_ge_u32 s21, 8
    s_cbranch_scc1 K1_H
Q_LOOP:
    s_cmp_lt_u32 s25, 7
    s_cbranch_scc1 Q_W5
    s_waitcnt vmcnt(0)
Q_W5:
    s_waitcnt vmcnt(5)
    s_barrier
    v_mfma_f32_32x32x16_bf16 v[64:79], v[132:135], v[128:131], v[64:79]
    ds_read_b128 v[112:115], v5
    ds_read_b64_tr_b16 v[116:117], v36 offset:0
    ds_read_b64_tr_b16 v[118:119], v36 offset:512
    ds_read_b64_tr_b16 v[120:121], v36 offset:8192
    ds_read_b64_tr_b16 v[122:123], v36 offset:8704
    ds_read_b64_tr_b16 v[124:125], v36 offset:16384
    ds_read_b64_tr_b16 v[126:127], v36 offset:16896
    v_mfma_f32_32x32x16_bf16 v[80:95], v[136:139], v[128:131], v[80:95]
    s_cmp_ge_u32 s25, 6
    s_cbranch_scc1 Q_S1
    s_add_u32 m0, s26, s50
    s_add_u32 s53, s28, s29
    buffer_load_dwordx4 v2, s[4:7], s27 offen lds
    s_add_u32 m0, m0, 1024
    s_add_u32 s54, s53, s29
    buffer_load_dwordx4 v3, s[4:7], s27 offen lds
Q_S1:
    v_mfma_f32_32x32x16_bf16 v[96:111], v[128:131], v[140:143], v[96:111]
    v_mfma_f32_16x16x32_bf16 v[156:159], v[160:163], v[140:143], v[156:159]
    s_waitcnt lgkmcnt(0)
    v_mfma_f32_32x32x16_bf16 v[64:79], v[116:119], v[112:115], v[64:79]
    ds_read_b128 v[128:131], v6
    ds_read_b64_tr_b16 v[132:133], v37 offset:0
    ds_read_b64_tr_b16 v[134:135], v37 offset:512
    ds_read_b64_tr_b16 v[136:137], v37 offset:8192
    ds_read_b64_tr_b16 v[138:139], v37 offset:8704
    ds_read_b64_tr_b16 v[140:141], v37 offset:16384
    ds_read_b64_tr_b16 v[142:143], v37 offset:16896
    v_mfma_f32_32x32x16_bf16 v[80:95], v[120:123], v[112:115], v[80:95]
    s_cmp_ge_u32 s25, 6
    s_cbranch_scc1 Q_S2
    s_add_u32 m0, s26, s51
    s_add_u32 s27, s27, 128
    buffer_load_dwordx4 v4, s[8:11], s28 offen lds
    s_add_u32 m0, m0, 8192
    s_add_u32 s28, s28, s30
    buffer_load_dwordx4 v4, s[8:11], s53 offen lds
    s_add_u32 m0, m0, 8192
    s_add_u32 s26, s26, 40960
    buffer_load_dwordx4 v4, s[8:11], s54 offen lds
Q_S2:
    v_lshlrev_b32 v20, 16, v112
    v_and_b32 v21, s55, v112
    v_fmac_f32 v12, v20, v20
    v_fmac_f32 v13, v21, v21
    v_lshlrev_b32 v22, 16, v113
    v_and_b32 v23, s55, v113
    v_fmac_f32 v12, v22, v22
    v_fmac_f32 v13, v23, v23
    v_mfma_f32_32x32x16_bf16 v[96:111], v[112:115], v[124:127], v[96:111]
    v_lshlrev_b32 v20, 16, v114
    v_and_b32 v21, s55, v114
    v_fmac_f32 v12, v20, v20
    v_fmac_f32 v13, v21, v21
    v_lshlrev_b32 v22, 16, v115
    v_and_b32 v23, s55, v115
    v_fmac_f32 v12, v22, v22
    v_fmac_f32 v13, v23, v23
    v_mfma_f32_16x16x32_bf16 v[144:147], v[160:163], v[112:115], v[144:147]
    s_waitcnt lgkmcnt(0)
    v_mfma_f32_32x32x16_bf16 v[64:79], v[132:135], v[128:131], v[64:79]
    ds_read_b128 v[112:115], v7
    ds_read_b64_tr_b16 v[116:117], v38 offset:0
    ds_read_b64_tr_b16 v[118:119], v38 offset:512
    ds_read_b64_tr_b16 v[120:121], v38 offset:8192
    ds_read_b64_tr_b16 v[122:123], v38 offset:8704
    ds_read_b64_tr_b16 v[124:125], v38 offset:16384
    ds_read_b64_tr_b16 v[126:127], v38 offset:16896
    v_mfma_f32_32x32x16_bf16 v[80:95], v[136:139], v[128:131], v[80:95]
    v_mfma_f32_16x16x32_bf16 v[148:151], v[160:163], v[132:135], v[148:151]
    v_mfma_f32_32x32x16_bf16 v[96:111], v[128:131], v[140:143], v[96:111]
    v_mfma_f32_16x16x32_bf16 v[152:155], v[160:163], v[136:139], v[152:155]
    s_add_u32 s25, s25, 1
    s_add_u32 s60, s60, 1
    s_cmp_eq_u32 s60, 3
    s_cselect_b32 s47, s59, 40960
    s_cselect_b32 s60, 0, s60
    s_waitcnt lgkmcnt(0)
    v_mfma_f32_32x32x16_bf16 v[64:79], v[116:119], v[112:115], v[64:79]
    ds_read_b128 v[128:131], v8
    ds_read_b64_tr_b16 v[132:133], v39 offset:0
    ds_read_b64_tr_b16 v[134:135], v39 offset:512
    ds_read_b64_tr_b16 v[136:137], v39 offset:8192
    ds_read_b64_tr_b16 v[138:139], v39 offset:8704
    ds_read_b64_tr_b16 v[140:141], v39 offset:16384
    ds_read_b64_tr_b16 v[142:143], v39 offset:16896
    v_mfma_f32_32x32x16_bf16 v[80:95], v[120:123], v[112:115], v[80:95]
    v_lshlrev_b32 v20, 16, v112
    v_and_b32 v21, s55, v112
    v_fmac_f32 v12, v20, v20
    v_fmac_f32 v13, v21, v21
    v_lshlrev_b32 v22, 16, v113
    v_and_b32 v23, s55, v113
    v_fmac_f32 v12, v22, v22
    v_fmac_f32 v13, v23, v23
    v_add_u32 v5, s47, v5
    v_add_u32 v6, s47, v6
    v_add_u32 v7, s47, v7
    v_add_u32 v8, s47, v8
    v_mfma_f32_32x32x16_bf16 v[96:111], v[112:115], v[124:127], v[96:111]
    v_lshlrev_b32 v20, 16, v114
    v_and_b32 v21, s55, v114
    v_fmac_f32 v12, v20, v20
    v_fmac_f32 v13, v21, v21
    v_lshlrev_b32 v22, 16, v115
    v_and_b32 v23, s55, v115
    v_fmac_f32 v12, v22, v22
    v_fmac_f32 v13, v23, v23
    v_mfma_f32_16x16x32_bf16 v[144:147], v[160:163], v[112:115], v[144:147]
    v_add_u32 v36, s47, v36
    v_add_u32 v37, s47, v37
    v_add_u32 v38, s47, v38
    v_add_u32 v39, s47, v39
    s_cmp_eq_u32 s26, 122880
    s_cselect_b32 s26, 0, s26
    s_cmp_lt_u32 s25, 8
    s_waitcnt lgkmcnt(0)
    s_cbranch_scc1 Q_LOOP
    v_mfma_f32_32x32x16_bf16 v[64:79], v[132:135], v[128:131], v[64:79]
    v_mfma_f32_32x32x16_bf16 v[80:95], v[136:139], v[128:131], v[80:95]
    v_mfma_f32_32x32x16_bf16 v[96:111], v[128:131], v[140:143], v[96:111]
    v_mfma_f32_16x16x32_bf16 v[156:159], v[160:163], v[140:143], v[156:159]
    v_mov_b32 v10, v144
    v_add_f32 v12, v12, v13
    v_mov_b32 v14, v148
    v_mov_b32 v16, v152
    s_nop 3
    v_mov_b32 v18, v156
    v_mov_b32 v19, v156
s_nop 1
    v_permlane32_swap_b32 v10, v12
s_nop 1
    v_permlane32_swap_b32 v14, v16
s_nop 1
    v_permlane32_swap_b32 v18, v19
    s_lshl_b32 s47, s24, 9
    s_lshl_b32 s53, s23, 7
    s_add_u32 s47, s47, s53
    s_add_u32 s47, s47, 131072
    v_lshlrev_b32 v20, 2, v27
    v_lshl_add_u32 v21, v26, 10, v20
    v_add_u32 v21, s47, v21
    s_mul_i32 s47, s23, 768
    s_lshl_b32 s53, s24, 7
    s_add_u32 s47, s47, s53
    s_add_u32 s47, s47, 131072
    v_add_u32 v20, s47, v20
    v_lshl_add_u32 v22, v26, 8, v20
    v_add_f32 v10, v10, v12
    v_add_f32 v14, v14, v16
    v_add_f32 v18, v18, v19
    ds_write_b32 v21, v10
    ds_write_b32 v22, v14 offset:2048
    ds_write_b32 v20, v18 offset:2560
    s_lshl_b32 s47, s23, 7
    s_add_u32 s47, s47, 131072
    v_lshlrev_b32 v20, 2, v27
    v_add_u32 v22, s47, v20
    s_lshl_b32 s53, s24, 7
    s_add_u32 s53, s53, 131072
    v_add_u32 v21, s53, v20
    v_bfe_u32 v23, v1, 2, 2
    v_lshl_add_u32 v23, v26, 2, v23
    v_lshlrev_b32 v23, 5, v23
    v_and_b32 v24, 3, v1
    v_lshl_add_u32 v23, v24, 3, v23
    s_add_u32 s47, s51, 122880-16384
    v_add_u32 v23, s47, v23
    ds_read_b64_tr_b16 v[28:29], v23 offset:0
    ds_read_b64_tr_b16 v[30:31], v23 offset:256
    ds_read_b64_tr_b16 v[32:33], v23 offset:512
    ds_read_b64_tr_b16 v[34:35], v23 offset:768
    s_waitcnt lgkmcnt(0)
    s_barrier
    ds_read_b32 v10, v22 offset:0
    ds_read_b32 v11, v22 offset:512
    ds_read_b32 v12, v22 offset:1024
    ds_read_b32 v13, v22 offset:1536
    ds_read_b32 v112, v21 offset:2048
    ds_read_b32 v113, v21 offset:2816
    ds_read_b32 v114, v21 offset:3584
    ds_read_b32 v115, v21 offset:4352
    ds_read_b32 v116, v21 offset:2304
    ds_read_b32 v117, v21 offset:3072
    ds_read_b32 v118, v21 offset:3840
    ds_read_b32 v119, v21 offset:4608
    ds_read_b32 v120, v21 offset:2560
    ds_read_b32 v121, v21 offset:3328
    ds_read_b32 v122, v21 offset:4096
    ds_read_b32 v123, v21 offset:4864
    v_and_b32 v23, 16, v1
    v_mul_u32_u24 v23, 0x800, v23
    v_lshl_or_b32 v23, v23, 16, v23
    v_xor_b32 v28, v23, v28
    v_xor_b32 v29, v23, v29
    v_xor_b32 v30, v23, v30
    v_xor_b32 v31, v23, v31
    v_xor_b32 v32, v23, v32
    v_xor_b32 v33, v23, v33
    v_xor_b32 v34, v23, v34
    v_xor_b32 v35, v23, v35
    v_mov_b32 v135, 0
    v_mov_b32 v134, 0
    v_mov_b32 v139, 0
    v_mov_b32 v138, 0
    v_mov_b32 v143, 0
    v_mov_b32 v142, 0
    v_cmp_gt_u32 vcc, 32, v1
    v_mov_b32 v131, 0
    s_waitcnt lgkmcnt(12)
    v_add_f32 v10, v10, v11
    v_add_f32 v12, v12, v13
    v_mul_f32 v10, 0xbb000000, v10
    v_mul_f32 v11, v10, v10
    v_mov_b32 v13, 0x3b000000
    v_fma_f32 v12, v12, v13, -v11
    v_max_f32 v12, 0, v12
    v_add_f32 v11, 0x3727c5ac, v12
    v_rsq_f32 v11, v11
    v_cvt_pk_bf16_f32 v13, v10, v10
    v_lshlrev_b32 v13, 16, v13
    v_sub_f32 v13, v10, v13
    v_cvt_pk_bf16_f32 v13, v10, v13
    v_cndmask_b32 v128, 0, v13, vcc
    v_mov_b32 v129, v128
    v_mov_b32 v130, 0
    s_lshl_b32 s47, s22, 7
    v_add_u32 v20, s47, v20
    ds_write_b32 v20, v11 offset:8192
    v_lshlrev_b32 v23, 4, v26
    v_add_u32 v23, s47, v23
    s_waitcnt lgkmcnt(1)
    v_add_f32 v116, v116, v117
    v_add_f32 v118, v118, v119
    v_add_f32 v116, v116, v118
    v_cvt_pk_bf16_f32 v136, v116, v116
    v_lshlrev_b32 v117, 16, v136
    v_sub_f32 v116, v116, v117
    v_cvt_pk_bf16_f32 v137, v116, v116
    s_nop 1
    v_mfma_f32_32x32x16_bf16 v[80:95], v[136:139], v[128:131], v[80:95]
    v_add_f32 v112, v112, v113
    v_add_f32 v114, v114, v115
    v_add_f32 v112, v112, v114
    v_cvt_pk_bf16_f32 v132, v112, v112
    v_lshlrev_b32 v113, 16, v132
    v_sub_f32 v112, v112, v113
    v_cvt_pk_bf16_f32 v133, v112, v112
    s_nop 1
    v_mfma_f32_32x32x16_bf16 v[64:79], v[132:135], v[128:131], v[64:79]
    v_add_f32 v120, v120, v121
    v_add_f32 v122, v122, v123
    v_add_f32 v120, v120, v122
    v_cvt_pk_bf16_f32 v140, v120, v120
    v_lshlrev_b32 v121, 16, v140
    v_sub_f32 v120, v120, v121
    v_cvt_pk_bf16_f32 v141, v120, v120
    s_nop 1
    v_mfma_f32_32x32x16_bf16 v[96:111], v[128:131], v[140:143], v[96:111]
    s_waitcnt lgkmcnt(0)
    ds_read_b128 v[160:163], v23 offset:8192
    ds_read_b128 v[164:167], v23 offset:8224
    ds_read_b128 v[168:171], v23 offset:8256
    ds_read_b128 v[172:175], v23 offset:8288
    s_lshl_b32 s47, s20, 2
    s_add_u32 s47, s47, s23
    s_lshl_b32 s47, s47, 5
    s_add_u32 s47, s47, s56
    s_lshl_b32 s47, s47, 11
    s_add_u32 s57, s47, 6291456
    v_lshlrev_b32 v25, 4, v1
    s_mul_i32 s47, s24, 18432
    s_mul_i32 s53, s23, 2304
    s_add_u32 s47, s47, s53
    v_mul_u32_u24 v24, 72, v27
    v_lshl_add_u32 v24, v26, 3, v24
    v_add_u32 v24, s47, v24
    s_mov_b32 s58, 0x3fb8aa3b
    v_pk_mul_f32 v[80:81], v[80:81], v[10:11] op_sel:[0,1]
    v_pk_mul_f32 v[82:83], v[82:83], v[10:11] op_sel:[0,1]
    v_pk_mul_f32 v[84:85], v[84:85], v[10:11] op_sel:[0,1]
    v_pk_mul_f32 v[86:87], v[86:87], v[10:11] op_sel:[0,1]
    v_pk_mul_f32 v[88:89], v[88:89], v[10:11] op_sel:[0,1]
    v_pk_mul_f32 v[90:91], v[90:91], v[10:11] op_sel:[0,1]
    v_pk_mul_f32 v[92:93], v[92:93], v[10:11] op_sel:[0,1]
    v_pk_mul_f32 v[94:95], v[94:95], v[10:11] op_sel:[0,1]
    v_cvt_pk_bf16_f32 v48, v80, v81
    v_cvt_pk_bf16_f32 v49, v82, v83
    v_cvt_pk_bf16_f32 v50, v84, v85
    v_cvt_pk_bf16_f32 v51, v86, v87
    v_cvt_pk_bf16_f32 v52, v88, v89
    v_cvt_pk_bf16_f32 v53, v90, v91
    v_cvt_pk_bf16_f32 v54, v92, v93
    v_cvt_pk_bf16_f32 v55, v94, v95
    v_mfma_f32_32x32x16_bf16 v[208:223], v[28:31], v[48:51], 0
    s_nop 0
    v_mfma_f32_32x32x16_bf16 v[224:239], v[32:35], v[52:55], 0
    v_pk_mul_f32 v[64:65], v[64:65], v[10:11] op_sel:[0,1]
    v_pk_mul_f32 v[66:67], v[66:67], v[10:11] op_sel:[0,1]
    v_pk_mul_f32 v[68:69], v[68:69], v[10:11] op_sel:[0,1]
    v_pk_mul_f32 v[70:71], v[70:71], v[10:11] op_sel:[0,1]
    v_pk_mul_f32 v[72:73], v[72:73], v[10:11] op_sel:[0,1]
    v_pk_mul_f32 v[74:75], v[74:75], v[10:11] op_sel:[0,1]
    v_pk_mul_f32 v[76:77], v[76:77], v[10:11] op_sel:[0,1]
    v_pk_mul_f32 v[78:79], v[78:79], v[10:11] op_sel:[0,1]
    v_cvt_pk_bf16_f32 v40, v64, v65
    v_cvt_pk_bf16_f32 v41, v66, v67
    v_cvt_pk_bf16_f32 v42, v68, v69
    v_cvt_pk_bf16_f32 v43, v70, v71
    v_cvt_pk_bf16_f32 v44, v72, v73
    v_cvt_pk_bf16_f32 v45, v74, v75
    v_cvt_pk_bf16_f32 v46, v76, v77
    v_cvt_pk_bf16_f32 v47, v78, v79
    v_mfma_f32_32x32x16_bf16 v[176:191], v[28:31], v[40:43], 0
    s_nop 0
    v_mfma_f32_32x32x16_bf16 v[192:207], v[32:35], v[44:47], 0
    s_waitcnt lgkmcnt(0)
    v_pk_mul_f32 v[96:97], v[96:97], v[160:161]
    v_pk_mul_f32 v[98:99], v[98:99], v[162:163]
    v_pk_mul_f32 v[100:101], v[100:101], v[164:165]
    v_pk_mul_f32 v[102:103], v[102:103], v[166:167]
    v_pk_mul_f32 v[104:105], v[104:105], v[168:169]
    v_pk_mul_f32 v[106:107], v[106:107], v[170:171]
    v_pk_mul_f32 v[108:109], v[108:109], v[172:173]
    v_pk_mul_f32 v[110:111], v[110:111], v[174:175]
    v_mov_b32 v112, 0x3f803f80
    v_mov_b32 v113, v112
    v_mov_b32 v114, v112
    v_mov_b32 v115, v112
    s_lshl_b32 s47, s22, 10
    s_add_u32 s47, s47, 16384
    v_add_u32 v116, s47, v25
    ds_write_b128 v116, v[112:115] offset:53248
    v_cvt_pk_bf16_f32 v40, v96, v97
    v_cvt_pk_bf16_f32 v41, v98, v99
    v_cvt_pk_bf16_f32 v42, v100, v101
    v_cvt_pk_bf16_f32 v43, v102, v103
    v_cvt_pk_bf16_f32 v44, v104, v105
    v_cvt_pk_bf16_f32 v45, v106, v107
    v_cvt_pk_bf16_f32 v46, v108, v109
    v_cvt_pk_bf16_f32 v47, v110, v111
    s_lshl_b32 s47, s22, 11
    v_add_u32 v23, s47, v25
    ds_write_b128 v23, v[40:43] offset:53248
    ds_write_b128 v23, v[44:47] offset:54272
    v_max3_f32 v10, v208, v209, v210
    v_max3_f32 v14, v224, v225, v226
    v_max3_f32 v11, v216, v217, v218
    v_max3_f32 v15, v232, v233, v234
    v_max3_f32 v10, v10, v211, v212
    v_max3_f32 v14, v14, v227, v228
    v_max3_f32 v11, v11, v219, v220
    v_max3_f32 v15, v15, v235, v236
    v_max3_f32 v10, v10, v213, v214
    v_max3_f32 v14, v14, v229, v230
    v_max3_f32 v11, v11, v221, v222
    v_max3_f32 v15, v15, v237, v238
    v_max_f32 v10, v10, v215
    v_max_f32 v14, v14, v231
    v_max_f32 v11, v11, v223
    v_max_f32 v15, v15, v239
    s_nop 0
s_nop 1
    v_permlane32_swap_b32 v10, v11
s_nop 1
    v_permlane32_swap_b32 v14, v15
    v_max_f32 v10, v10, v11
    v_max_f32 v14, v14, v15
    v_mul_f32 v10, s58, v10
    v_mul_f32 v14, s58, v14
    v_mov_b32 v11, v10
    v_mov_b32 v15, v14
    s_nop 0
s_nop 1
    v_permlane32_swap_b32 v10, v11
s_nop 1
    v_permlane32_swap_b32 v14, v15
    v_pk_fma_f32 v[208:209], v[208:209], s[58:59], v[10:11] op_sel_hi:[1,0,0] neg_lo:[0,0,1] neg_hi:[0,0,1]
    v_pk_fma_f32 v[224:225], v[224:225], s[58:59], v[14:15] op_sel_hi:[1,0,0] neg_lo:[0,0,1] neg_hi:[0,0,1]
    v_pk_fma_f32 v[210:211], v[210:211], s[58:59], v[10:11] op_sel_hi:[1,0,0] neg_lo:[0,0,1] neg_hi:[0,0,1]
    v_pk_fma_f32 v[226:227], v[226:227], s[58:59], v[14:15] op_sel_hi:[1,0,0] neg_lo:[0,0,1] neg_hi:[0,0,1]
    v_pk_fma_f32 v[212:213], v[212:213], s[58:59], v[10:11] op_sel_hi:[1,0,0] neg_lo:[0,0,1] neg_hi:[0,0,1]
    v_pk_fma_f32 v[228:229], v[228:229], s[58:59], v[14:15] op_sel_hi:[1,0,0] neg_lo:[0,0,1] neg_hi:[0,0,1]
    v_pk_fma_f32 v[214:215], v[214:215], s[58:59], v[10:11] op_sel_hi:[1,0,0] neg_lo:[0,0,1] neg_hi:[0,0,1]
    v_pk_fma_f32 v[230:231], v[230:231], s[58:59], v[14:15] op_sel_hi:[1,0,0] neg_lo:[0,0,1] neg_hi:[0,0,1]
    v_pk_fma_f32 v[216:217], v[216:217], s[58:59], v[10:11] op_sel:[0,0,1] op_sel_hi:[1,0,1] neg_lo:[0,0,1] neg_hi:[0,0,1]
    v_pk_fma_f32 v[232:233], v[232:233], s[58:59], v[14:15] op_sel:[0,0,1] op_sel_hi:[1,0,1] neg_lo:[0,0,1] neg_hi:[0,0,1]
    v_pk_fma_f32 v[218:219], v[218:219], s[58:59], v[10:11] op_sel:[0,0,1] op_sel_hi:[1,0,1] neg_lo:[0,0,1] neg_hi:[0,0,1]
    v_pk_fma_f32 v[234:235], v[234:235], s[58:59], v[14:15] op_sel:[0,0,1] op_sel_hi:[1,0,1] neg_lo:[0,0,1] neg_hi:[0,0,1]
    v_pk_fma_f32 v[220:221], v[220:221], s[58:59], v[10:11] op_sel:[0,0,1] op_sel_hi:[1,0,1] neg_lo:[0,0,1] neg_hi:[0,0,1]
    v_pk_fma_f32 v[236:237], v[236:237], s[58:59], v[14:15] op_sel:[0,0,1] op_sel_hi:[1,0,1] neg_lo:[0,0,1] neg_hi:[0,0,1]
    v_pk_fma_f32 v[222:223], v[222:223], s[58:59], v[10:11] op_sel:[0,0,1] op_sel_hi:[1,0,1] neg_lo:[0,0,1] neg_hi:[0,0,1]
    v_pk_fma_f32 v[238:239], v[238:239], s[58:59], v[14:15] op_sel:[0,0,1] op_sel_hi:[1,0,1] neg_lo:[0,0,1] neg_hi:[0,0,1]
    v_exp_f32 v208, v208
    v_exp_f32 v224, v224
    v_exp_f32 v209, v209
    v_exp_f32 v225, v225
    v_exp_f32 v210, v210
    v_exp_f32 v226, v226
    v_exp_f32 v211, v211
    v_exp_f32 v227, v227
    v_exp_f32 v212, v212
    v_exp_f32 v228, v228
    v_exp_f32 v213, v213
    v_exp_f32 v229, v229
    v_exp_f32 v214, v214
    v_exp_f32 v230, v230
    v_exp_f32 v215, v215
    v_exp_f32 v231, v231
    v_exp_f32 v216, v216
    v_exp_f32 v232, v232
    v_exp_f32 v217, v217
    v_exp_f32 v233, v233
    v_exp_f32 v218, v218
    v_exp_f32 v234, v234
    v_exp_f32 v219, v219
    v_exp_f32 v235, v235
    v_exp_f32 v220, v220
    v_exp_f32 v236, v236
    v_exp_f32 v221, v221
    v_exp_f32 v237, v237
    v_exp_f32 v222, v222
    v_exp_f32 v238, v238
    v_exp_f32 v223, v223
    v_exp_f32 v239, v239
    v_pk_add_f32 v[2:3], v[208:209], v[210:211]
    v_pk_add_f32 v[6:7], v[224:225], v[226:227]
    v_pk_add_f32 v[4:5], v[216:217], v[218:219]
    v_pk_add_f32 v[36:37], v[232:233], v[234:235]
    v_pk_add_f32 v[2:3], v[2:3], v[212:213]
    v_pk_add_f32 v[6:7], v[6:7], v[228:229]
    v_pk_add_f32 v[4:5], v[4:5], v[220:221]
    v_pk_add_f32 v[36:37], v[36:37], v[236:237]
    v_pk_add_f32 v[2:3], v[2:3], v[214:215]
    v_pk_add_f32 v[6:7], v[6:7], v[230:231]
    v_pk_add_f32 v[4:5], v[4:5], v[222:223]
    v_pk_add_f32 v[36:37], v[36:37], v[238:239]
    v_add_f32 v10, v2, v3
    v_add_f32 v14, v6, v7
    v_add_f32 v11, v4, v5
    v_add_f32 v15, v36, v37
    s_nop 0
s_nop 1
    v_permlane32_swap_b32 v10, v11
s_nop 1
    v_permlane32_swap_b32 v14, v15
    v_add_f32 v10, v10, v11
    v_add_f32 v14, v14, v15
    v_rcp_f32 v10, v10
    v_rcp_f32 v14, v14
    v_mov_b32 v11, v10
    v_mov_b32 v15, v14
    s_nop 0
s_nop 1
    v_permlane32_swap_b32 v10, v11
s_nop 1
    v_permlane32_swap_b32 v14, v15
    v_pk_mul_f32 v[208:209], v[208:209], v[10:11] op_sel_hi:[1,0]
    v_pk_mul_f32 v[224:225], v[224:225], v[14:15] op_sel_hi:[1,0]
    v_pk_mul_f32 v[210:211], v[210:211], v[10:11] op_sel_hi:[1,0]
    v_pk_mul_f32 v[226:227], v[226:227], v[14:15] op_sel_hi:[1,0]
    v_pk_mul_f32 v[212:213], v[212:213], v[10:11] op_sel_hi:[1,0]
    v_pk_mul_f32 v[228:229], v[228:229], v[14:15] op_sel_hi:[1,0]
    v_pk_mul_f32 v[214:215], v[214:215], v[10:11] op_sel_hi:[1,0]
    v_pk_mul_f32 v[230:231], v[230:231], v[14:15] op_sel_hi:[1,0]
    v_pk_mul_f32 v[216:217], v[216:217], v[10:11] op_sel:[0,1]
    v_pk_mul_f32 v[232:233], v[232:233], v[14:15] op_sel:[0,1]
    v_pk_mul_f32 v[218:219], v[218:219], v[10:11] op_sel:[0,1]
    v_pk_mul_f32 v[234:235], v[234:235], v[14:15] op_sel:[0,1]
    v_pk_mul_f32 v[220:221], v[220:221], v[10:11] op_sel:[0,1]
    v_pk_mul_f32 v[236:237], v[236:237], v[14:15] op_sel:[0,1]
    v_pk_mul_f32 v[222:223], v[222:223], v[10:11] op_sel:[0,1]
    v_pk_mul_f32 v[238:239], v[238:239], v[14:15] op_sel:[0,1]
    v_cvt_pk_bf16_f32 v48, v208, v209
    v_cvt_pk_bf16_f32 v56, v224, v225
    v_cvt_pk_bf16_f32 v49, v210, v211
    v_cvt_pk_bf16_f32 v57, v226, v227
    v_cvt_pk_bf16_f32 v50, v212, v213
    v_cvt_pk_bf16_f32 v58, v228, v229
    v_cvt_pk_bf16_f32 v51, v214, v215
    v_cvt_pk_bf16_f32 v59, v230, v231
    v_cvt_pk_bf16_f32 v52, v216, v217
    v_cvt_pk_bf16_f32 v60, v232, v233
    v_cvt_pk_bf16_f32 v53, v218, v219
    v_cvt_pk_bf16_f32 v61, v234, v235
    v_cvt_pk_bf16_f32 v54, v220, v221
    v_cvt_pk_bf16_f32 v62, v236, v237
    v_cvt_pk_bf16_f32 v55, v222, v223
    v_cvt_pk_bf16_f32 v63, v238, v239
    ds_write_b64 v24, v[48:49] offset:16384
    ds_write_b64 v24, v[50:51] offset:16400
    ds_write_b64 v24, v[52:53] offset:16416
    ds_write_b64 v24, v[54:55] offset:16432
    ds_write_b64 v24, v[56:57] offset:25600
    ds_write_b64 v24, v[58:59] offset:25616
    ds_write_b64 v24, v[60:61] offset:25632
    ds_write_b64 v24, v[62:63] offset:25648
    s_waitcnt lgkmcnt(0)
    s_barrier
    v_bfe_u32 v20, v1, 2, 2
    v_lshl_add_u32 v20, v26, 2, v20
    v_mul_u32_u24 v20, 72, v20
    v_bfe_u32 v21, v1, 4, 1
    v_lshl_add_u32 v20, v21, 5, v20
    v_and_b32 v22, 3, v1
    v_lshl_add_u32 v20, v22, 3, v20
    s_mul_i32 s47, s23, 9216
    v_add_u32 v20, s47, v20
    s_lshr_b32 s47, s23, 1
    s_lshl_b32 s47, s47, 13
    v_add_u32 v22, s47, v25
    s_and_b32 s47, s22, 1
    v_cmp_ne_u32 vcc, s47, v21
    v_add_u32 v21, 16384, v25
    s_nop 0
    v_cndmask_b32 v22, v22, v21, vcc
    ds_read_b64_tr_b16 v[64:65], v20 offset:16384
    ds_read_b64_tr_b16 v[66:67], v20 offset:16960
    ds_read_b128 v[112:115], v22 offset:53248
    ds_read_b64_tr_b16 v[68:69], v20 offset:17536
    ds_read_b64_tr_b16 v[70:71], v20 offset:18112
    ds_read_b128 v[116:119], v22 offset:54272
    ds_read_b64_tr_b16 v[72:73], v20 offset:18688
    ds_read_b64_tr_b16 v[74:75], v20 offset:19264
    ds_read_b128 v[120:123], v22 offset:55296
    ds_read_b64_tr_b16 v[76:77], v20 offset:19840
    ds_read_b64_tr_b16 v[78:79], v20 offset:20416
    ds_read_b128 v[124:127], v22 offset:56320
    ds_read_b64_tr_b16 v[80:81], v20 offset:20992
    ds_read_b64_tr_b16 v[82:83], v20 offset:21568
    ds_read_b128 v[128:131], v22 offset:57344
    ds_read_b64_tr_b16 v[84:85], v20 offset:22144
    ds_read_b64_tr_b16 v[86:87], v20 offset:22720
    ds_read_b128 v[132:135], v22 offset:58368
    ds_read_b64_tr_b16 v[88:89], v20 offset:23296
    ds_read_b64_tr_b16 v[90:91], v20 offset:23872
    ds_read_b128 v[136:139], v22 offset:59392
    ds_read_b64_tr_b16 v[92:93], v20 offset:24448
    ds_read_b64_tr_b16 v[94:95], v20 offset:25024
    ds_read_b128 v[140:143], v22 offset:60416
    v_max3_f32 v10, v176, v177, v178
    v_max3_f32 v14, v192, v193, v194
    v_max3_f32 v11, v184, v185, v186
    v_max3_f32 v15, v200, v201, v202
    v_max3_f32 v10, v10, v179, v180
    v_max3_f32 v14, v14, v195, v196
    v_max3_f32 v11, v11, v187, v188
    v_max3_f32 v15, v15, v203, v204
    v_max3_f32 v10, v10, v181, v182
    v_max3_f32 v14, v14, v197, v198
    v_max3_f32 v11, v11, v189, v190
    v_max3_f32 v15, v15, v205, v206
    v_max_f32 v10, v10, v183
    v_max_f32 v14, v14, v199
    v_max_f32 v11, v11, v191
    v_max_f32 v15, v15, v207
    s_nop 0
s_nop 1
    v_permlane32_swap_b32 v10, v11
s_nop 1
    v_permlane32_swap_b32 v14, v15
    v_max_f32 v10, v10, v11
    v_max_f32 v14, v14, v15
    v_mul_f32 v10, s58, v10
    v_mul_f32 v14, s58, v14
    v_mov_b32 v11, v10
    v_mov_b32 v15, v14
    s_nop 0
s_nop 1
    v_permlane32_swap_b32 v10, v11
s_nop 1
    v_permlane32_swap_b32 v14, v15
    v_pk_fma_f32 v[176:177], v[176:177], s[58:59], v[10:11] op_sel_hi:[1,0,0] neg_lo:[0,0,1] neg_hi:[0,0,1]
    v_pk_fma_f32 v[192:193], v[192:193], s[58:59], v[14:15] op_sel_hi:[1,0,0] neg_lo:[0,0,1] neg_hi:[0,0,1]
    v_pk_fma_f32 v[178:179], v[178:179], s[58:59], v[10:11] op_sel_hi:[1,0,0] neg_lo:[0,0,1] neg_hi:[0,0,1]
    v_pk_fma_f32 v[194:195], v[194:195], s[58:59], v[14:15] op_sel_hi:[1,0,0] neg_lo:[0,0,1] neg_hi:[0,0,1]
    v_pk_fma_f32 v[180:181], v[180:181], s[58:59], v[10:11] op_sel_hi:[1,0,0] neg_lo:[0,0,1] neg_hi:[0,0,1]
    v_pk_fma_f32 v[196:197], v[196:197], s[58:59], v[14:15] op_sel_hi:[1,0,0] neg_lo:[0,0,1] neg_hi:[0,0,1]
    v_pk_fma_f32 v[182:183], v[182:183], s[58:59], v[10:11] op_sel_hi:[1,0,0] neg_lo:[0,0,1] neg_hi:[0,0,1]
    v_pk_fma_f32 v[198:199], v[198:199], s[58:59], v[14:15] op_sel_hi:[1,0,0] neg_lo:[0,0,1] neg_hi:[0,0,1]
    v_pk_fma_f32 v[184:185], v[184:185], s[58:59], v[10:11] op_sel:[0,0,1] op_sel_hi:[1,0,1] neg_lo:[0,0,1] neg_hi:[0,0,1]
    v_pk_fma_f32 v[200:201], v[200:201], s[58:59], v[14:15] op_sel:[0,0,1] op_sel_hi:[1,0,1] neg_lo:[0,0,1] neg_hi:[0,0,1]
    v_pk_fma_f32 v[186:187], v[186:187], s[58:59], v[10:11] op_sel:[0,0,1] op_sel_hi:[1,0,1] neg_lo:[0,0,1] neg_hi:[0,0,1]
    v_pk_fma_f32 v[202:203], v[202:203], s[58:59], v[14:15] op_sel:[0,0,1] op_sel_hi:[1,0,1] neg_lo:[0,0,1] neg_hi:[0,0,1]
    v_pk_fma_f32 v[188:189], v[188:189], s[58:59], v[10:11] op_sel:[0,0,1] op_sel_hi:[1,0,1] neg_lo:[0,0,1] neg_hi:[0,0,1]
    v_pk_fma_f32 v[204:205], v[204:205], s[58:59], v[14:15] op_sel:[0,0,1] op_sel_hi:[1,0,1] neg_lo:[0,0,1] neg_hi:[0,0,1]
    v_pk_fma_f32 v[190:191], v[190:191], s[58:59], v[10:11] op_sel:[0,0,1] op_sel_hi:[1,0,1] neg_lo:[0,0,1] neg_hi:[0,0,1]
    v_pk_fma_f32 v[206:207], v[206:207], s[58:59], v[14:15] op_sel:[0,0,1] op_sel_hi:[1,0,1] neg_lo:[0,0,1] neg_hi:[0,0,1]
    s_waitcnt lgkmcnt(0)
    v_exp_f32 v176, v176
    v_exp_f32 v192, v192
    v_exp_f32 v177, v177
    v_exp_f32 v193, v193
    v_mfma_f32_32x32x16_bf16 v[208:223], v[64:67], v[112:115], 0
    v_exp_f32 v178, v178
    v_exp_f32 v194, v194
    v_exp_f32 v179, v179
    v_exp_f32 v195, v195
    v_mfma_f32_32x32x16_bf16 v[208:223], v[68:71], v[116:119], v[208:223]
    v_exp_f32 v180, v180
    v_exp_f32 v196, v196
    v_exp_f32 v181, v181
    v_exp_f32 v197, v197
    v_mfma_f32_32x32x16_bf16 v[208:223], v[72:75], v[120:123], v[208:223]
    v_exp_f32 v182, v182
    v_exp_f32 v198, v198
    v_exp_f32 v183, v183
    v_exp_f32 v199, v199
    v_mfma_f32_32x32x16_bf16 v[208:223], v[76:79], v[124:127], v[208:223]
    v_exp_f32 v184, v184
    v_exp_f32 v200, v200
    v_exp_f32 v185, v185
    v_exp_f32 v201, v201
    v_mfma_f32_32x32x16_bf16 v[208:223], v[80:83], v[128:131], v[208:223]
    v_exp_f32 v186, v186
    v_exp_f32 v202, v202
    v_exp_f32 v187, v187
    v_exp_f32 v203, v203
    v_mfma_f32_32x32x16_bf16 v[208:223], v[84:87], v[132:135], v[208:223]
    v_exp_f32 v188, v188
    v_exp_f32 v204, v204
    v_exp_f32 v189, v189
    v_exp_f32 v205, v205
    v_mfma_f32_32x32x16_bf16 v[208:223], v[88:91], v[136:139], v[208:223]
    v_exp_f32 v190, v190
    v_exp_f32 v206, v206
    v_exp_f32 v191, v191
    v_exp_f32 v207, v207
    v_mfma_f32_32x32x16_bf16 v[208:223], v[92:95], v[140:143], v[208:223]
    v_pk_add_f32 v[2:3], v[176:177], v[178:179]
    v_pk_add_f32 v[6:7], v[192:193], v[194:195]
    v_pk_add_f32 v[4:5], v[184:185], v[186:187]
    v_pk_add_f32 v[36:37], v[200:201], v[202:203]
    v_pk_add_f32 v[2:3], v[2:3], v[180:181]
    v_pk_add_f32 v[6:7], v[6:7], v[196:197]
    v_pk_add_f32 v[4:5], v[4:5], v[188:189]
    v_pk_add_f32 v[36:37], v[36:37], v[204:205]
    v_pk_add_f32 v[2:3], v[2:3], v[182:183]
    v_pk_add_f32 v[6:7], v[6:7], v[198:199]
    v_pk_add_f32 v[4:5], v[4:5], v[190:191]
    v_pk_add_f32 v[36:37], v[36:37], v[206:207]
    v_add_f32 v10, v2, v3
    v_add_f32 v14, v6, v7
    v_add_f32 v11, v4, v5
    v_add_f32 v15, v36, v37
    s_nop 0
s_nop 1
    v_permlane32_swap_b32 v10, v11
s_nop 1
    v_permlane32_swap_b32 v14, v15
    v_add_f32 v10, v10, v11
    v_add_f32 v14, v14, v15
    v_rcp_f32 v10, v10
    v_rcp_f32 v14, v14
    v_mov_b32 v11, v10
    v_mov_b32 v15, v14
    s_nop 0
s_nop 1
    v_permlane32_swap_b32 v10, v11
s_nop 1
    v_permlane32_swap_b32 v14, v15
    s_cmp_ge_u32 s22, 4
    s_cbranch_scc1 Q_NOST
    s_lshl_b32 s47, s21, 2
    s_add_u32 s47, s47, s22
    s_lshl_b32 s47, s47, 4
    s_add_u32 s47, s47, s20
    s_lshl_b32 s47, s47, 12
    s_add_u32 s47, s47, 10485760
    buffer_store_dwordx4 v[208:211], v25, s[12:15], s47 offen offset:0 sc1
    buffer_store_dwordx4 v[212:215], v25, s[12:15], s47 offen offset:1024 sc1
    buffer_store_dwordx4 v[216:219], v25, s[12:15], s47 offen offset:2048 sc1
    buffer_store_dwordx4 v[220:223], v25, s[12:15], s47 offen offset:3072 sc1
Q_NOST:
    v_pk_mul_f32 v[176:177], v[176:177], v[10:11] op_sel_hi:[1,0]
    v_pk_mul_f32 v[192:193], v[192:193], v[14:15] op_sel_hi:[1,0]
    v_pk_mul_f32 v[178:179], v[178:179], v[10:11] op_sel_hi:[1,0]
    v_pk_mul_f32 v[194:195], v[194:195], v[14:15] op_sel_hi:[1,0]
    v_pk_mul_f32 v[180:181], v[180:181], v[10:11] op_sel_hi:[1,0]
    v_pk_mul_f32 v[196:197], v[196:197], v[14:15] op_sel_hi:[1,0]
    v_pk_mul_f32 v[182:183], v[182:183], v[10:11] op_sel_hi:[1,0]
    v_pk_mul_f32 v[198:199], v[198:199], v[14:15] op_sel_hi:[1,0]
    v_pk_mul_f32 v[184:185], v[184:185], v[10:11] op_sel:[0,1]
    v_pk_mul_f32 v[200:201], v[200:201], v[14:15] op_sel:[0,1]
    v_pk_mul_f32 v[186:187], v[186:187], v[10:11] op_sel:[0,1]
    v_pk_mul_f32 v[202:203], v[202:203], v[14:15] op_sel:[0,1]
    v_pk_mul_f32 v[188:189], v[188:189], v[10:11] op_sel:[0,1]
    v_pk_mul_f32 v[204:205], v[204:205], v[14:15] op_sel:[0,1]
    v_pk_mul_f32 v[190:191], v[190:191], v[10:11] op_sel:[0,1]
    v_pk_mul_f32 v[206:207], v[206:207], v[14:15] op_sel:[0,1]
    v_cvt_pk_bf16_f32 v48, v176, v177
    v_cvt_pk_bf16_f32 v56, v192, v193
    v_cvt_pk_bf16_f32 v49, v178, v179
    v_cvt_pk_bf16_f32 v57, v194, v195
    v_cvt_pk_bf16_f32 v50, v180, v181
    v_cvt_pk_bf16_f32 v58, v196, v197
    v_cvt_pk_bf16_f32 v51, v182, v183
    v_cvt_pk_bf16_f32 v59, v198, v199
    v_cvt_pk_bf16_f32 v52, v184, v185
    v_cvt_pk_bf16_f32 v60, v200, v201
    v_cvt_pk_bf16_f32 v53, v186, v187
    v_cvt_pk_bf16_f32 v61, v202, v203
    v_cvt_pk_bf16_f32 v54, v188, v189
    v_cvt_pk_bf16_f32 v62, v204, v205
    v_cvt_pk_bf16_f32 v55, v190, v191
    v_cvt_pk_bf16_f32 v63, v206, v207
    buffer_store_dwordx4 v[48:51], v25, s[12:15], s57 offen offset:0 sc1
    buffer_store_dwordx4 v[52:55], v25, s[12:15], s57 offen offset:1024 sc1
    buffer_store_dwordx4 v[56:59], v25, s[12:15], s57 offen offset:2048 sc1
    buffer_store_dwordx4 v[60:63], v25, s[12:15], s57 offen offset:3072 sc1
Q_END:
    s_endpgm
K1_H:
H_LOOP:
    s_cmp_lt_u32 s25, 7
    s_cbranch_scc1 H_W5
    s_waitcnt vmcnt(0)
H_W5:
    s_waitcnt vmcnt(5)
    s_barrier
    s_cmp_lg_u32 s25, 7
    s_cbranch_scc1 H_NPF
    s_mov_b32 s95, 0x20000
    s_bfe_u32 s47, s2, 0x40003
    s_lshl_b32 s47, s47, 3
    s_add_u32 s47, s47, s22
    s_cmp_lt_u32 s47, 86
    s_cselect_b32 s92, s90, s88
    s_cselect_b32 s93, s91, s89
    s_cselect_b32 s94, s61, 0x80000
    s_cselect_b32 s53, 0, 86
    s_sub_u32 s47, s47, s53
    s_lshl_b32 s47, s47, 14
    v_lshlrev_b32 v2, 7, v1
    v_add_u32 v3, 0x2000, v2
    buffer_load_dword v2, v2, s[92:95], s47 offen
    buffer_load_dword v3, v3, s[92:95], s47 offen
H_NPF:
    v_mfma_f32_32x32x16_bf16 v[64:79], v[132:135], v[128:131], v[64:79]
    ds_read_b128 v[112:115], v5
    ds_read_b64_tr_b16 v[116:117], v36 offset:0
    ds_read_b64_tr_b16 v[118:119], v36 offset:512
    ds_read_b64_tr_b16 v[120:121], v36 offset:8192
    ds_read_b64_tr_b16 v[122:123], v36 offset:8704
    ds_read_b64_tr_b16 v[124:125], v36 offset:16384
    ds_read_b64_tr_b16 v[126:127], v36 offset:16896
    v_mfma_f32_32x32x16_bf16 v[80:95], v[136:139], v[128:131], v[80:95]
    s_cmp_ge_u32 s25, 6
    s_cbranch_scc1 H_S1
    s_add_u32 m0, s26, s50
    s_add_u32 s53, s28, s29
    buffer_load_dwordx4 v2, s[4:7], s27 offen lds
    s_add_u32 m0, m0, 1024
    s_add_u32 s54, s53, s29
    buffer_load_dwordx4 v3, s[4:7], s27 offen lds
H_S1:
    v_mfma_f32_32x32x16_bf16 v[96:111], v[140:143], v[128:131], v[96:111]
    v_mfma_f32_16x16x32_bf16 v[156:159], v[160:163], v[140:143], v[156:159]
    s_waitcnt lgkmcnt(0)
    v_mfma_f32_32x32x16_bf16 v[64:79], v[116:119], v[112:115], v[64:79]
    ds_read_b128 v[128:131], v6
    ds_read_b64_tr_b16 v[132:133], v37 offset:0
    ds_read_b64_tr_b16 v[134:135], v37 offset:512
    ds_read_b64_tr_b16 v[136:137], v37 offset:8192
    ds_read_b64_tr_b16 v[138:139], v37 offset:8704
    ds_read_b64_tr_b16 v[140:141], v37 offset:16384
    ds_read_b64_tr_b16 v[142:143], v37 offset:16896
    v_mfma_f32_32x32x16_bf16 v[80:95], v[120:123], v[112:115], v[80:95]
    s_cmp_ge_u32 s25, 6
    s_cbranch_scc1 H_S2
    s_add_u32 m0, s26, s51
    s_add_u32 s27, s27, 128
    buffer_load_dwordx4 v4, s[8:11], s28 offen lds
    s_add_u32 m0, m0, 8192
    s_add_u32 s28, s28, s30
    buffer_load_dwordx4 v4, s[8:11], s53 offen lds
    s_add_u32 m0, m0, 8192
    s_add_u32 s26, s26, 40960
    buffer_load_dwordx4 v4, s[8:11], s54 offen lds
H_S2:
    v_lshlrev_b32 v20, 16, v112
    v_and_b32 v21, s55, v112
    v_fmac_f32 v12, v20, v20
    v_fmac_f32 v13, v21, v21
    v_lshlrev_b32 v22, 16, v113
    v_and_b32 v23, s55, v113
    v_fmac_f32 v12, v22, v22
    v_fmac_f32 v13, v23, v23
    v_mfma_f32_32x32x16_bf16 v[96:111], v[124:127], v[112:115], v[96:111]
    v_lshlrev_b32 v20, 16, v114
    v_and_b32 v21, s55, v114
    v_fmac_f32 v12, v20, v20
    v_fmac_f32 v13, v21, v21
    v_lshlrev_b32 v22, 16, v115
    v_and_b32 v23, s55, v115
    v_fmac_f32 v12, v22, v22
    v_fmac_f32 v13, v23, v23
    v_mfma_f32_16x16x32_bf16 v[144:147], v[160:163], v[112:115], v[144:147]
    s_waitcnt lgkmcnt(0)
    v_mfma_f32_32x32x16_bf16 v[64:79], v[132:135], v[128:131], v[64:79]
    ds_read_b128 v[112:115], v7
    ds_read_b64_tr_b16 v[116:117], v38 offset:0
    ds_read_b64_tr_b16 v[118:119], v38 offset:512
    ds_read_b64_tr_b16 v[120:121], v38 offset:8192
    ds_read_b64_tr_b16 v[122:123], v38 offset:8704
    ds_read_b64_tr_b16 v[124:125], v38 offset:16384
    ds_read_b64_tr_b16 v[126:127], v38 offset:16896
    v_mfma_f32_32x32x16_bf16 v[80:95], v[136:139], v[128:131], v[80:95]
    v_mfma_f32_16x16x32_bf16 v[148:151], v[160:163], v[132:135], v[148:151]
    v_mfma_f32_32x32x16_bf16 v[96:111], v[140:143], v[128:131], v[96:111]
    v_mfma_f32_16x16x32_bf16 v[152:155], v[160:163], v[136:139], v[152:155]
    s_add_u32 s25, s25, 1
    s_add_u32 s60, s60, 1
    s_cmp_eq_u32 s60, 3
    s_cselect_b32 s47, s59, 40960
    s_cselect_b32 s60, 0, s60
    s_waitcnt lgkmcnt(0)
    v_mfma_f32_32x32x16_bf16 v[64:79], v[116:119], v[112:115], v[64:79]
    ds_read_b128 v[128:131], v8
    ds_read_b64_tr_b16 v[132:133], v39 offset:0
    ds_read_b64_tr_b16 v[134:135], v39 offset:512
    ds_read_b64_tr_b16 v[136:137], v39 offset:8192
    ds_read_b64_tr_b16 v[138:139], v39 offset:8704
    ds_read_b64_tr_b16 v[140:141], v39 offset:16384
    ds_read_b64_tr_b16 v[142:143], v39 offset:16896
    v_mfma_f32_32x32x16_bf16 v[80:95], v[120:123], v[112:115], v[80:95]
    v_lshlrev_b32 v20, 16, v112
    v_and_b32 v21, s55, v112
    v_fmac_f32 v12, v20, v20
    v_fmac_f32 v13, v21, v21
    v_lshlrev_b32 v22, 16, v113
    v_and_b32 v23, s55, v113
    v_fmac_f32 v12, v22, v22
    v_fmac_f32 v13, v23, v23
    v_add_u32 v5, s47, v5
    v_add_u32 v6, s47, v6
    v_add_u32 v7, s47, v7
    v_add_u32 v8, s47, v8
    v_mfma_f32_32x32x16_bf16 v[96:111], v[124:127], v[112:115], v[96:111]
    v_lshlrev_b32 v20, 16, v114
    v_and_b32 v21, s55, v114
    v_fmac_f32 v12, v20, v20
    v_fmac_f32 v13, v21, v21
    v_lshlrev_b32 v22, 16, v115
    v_and_b32 v23, s55, v115
    v_fmac_f32 v12, v22, v22
    v_fmac_f32 v13, v23, v23
    v_mfma_f32_16x16x32_bf16 v[144:147], v[160:163], v[112:115], v[144:147]
    v_add_u32 v36, s47, v36
    v_add_u32 v37, s47, v37
    v_add_u32 v38, s47, v38
    v_add_u32 v39, s47, v39
    s_cmp_eq_u32 s26, 122880
    s_cselect_b32 s26, 0, s26
    s_cmp_lt_u32 s25, 8
    s_waitcnt lgkmcnt(0)
    s_cbranch_scc1 H_LOOP
    v_mfma_f32_32x32x16_bf16 v[64:79], v[132:135], v[128:131], v[64:79]
    v_mfma_f32_32x32x16_bf16 v[80:95], v[136:139], v[128:131], v[80:95]
    v_mfma_f32_32x32x16_bf16 v[96:111], v[140:143], v[128:131], v[96:111]
    v_mfma_f32_16x16x32_bf16 v[156:159], v[160:163], v[140:143], v[156:159]
    v_mov_b32 v10, v144
    v_add_f32 v12, v12, v13
    v_mov_b32 v14, v148
    v_mov_b32 v16, v152
    s_nop 3
    v_mov_b32 v18, v156
    v_mov_b32 v19, v156
s_nop 1
    v_permlane32_swap_b32 v10, v12
s_nop 1
    v_permlane32_swap_b32 v14, v16
s_nop 1
    v_permlane32_swap_b32 v18, v19
    s_lshl_b32 s47, s24, 9
    s_lshl_b32 s53, s23, 7
    s_add_u32 s47, s47, s53
    s_add_u32 s47, s47, 131072
    v_lshlrev_b32 v20, 2, v27
    v_lshl_add_u32 v21, v26, 10, v20
    v_add_u32 v21, s47, v21
    s_mul_i32 s47, s23, 768
    s_lshl_b32 s53, s24, 7
    s_add_u32 s47, s47, s53
    s_add_u32 s47, s47, 131072
    v_add_u32 v20, s47, v20
    v_lshl_add_u32 v22, v26, 8, v20
    v_add_f32 v10, v10, v12
    v_add_f32 v14, v14, v16
    v_add_f32 v18, v18, v19
    ds_write_b32 v21, v10
    ds_write_b32 v22, v14 offset:2048
    ds_write_b32 v20, v18 offset:2560
    s_lshl_b32 s47, s23, 7
    s_add_u32 s47, s47, 131072
    v_lshlrev_b32 v20, 2, v27
    v_add_u32 v22, s47, v20
    s_lshl_b32 s53, s24, 7
    s_add_u32 s53, s53, 131072
    v_add_u32 v21, s53, v20
    s_waitcnt lgkmcnt(0)
    s_barrier
    ds_read_b32 v10, v22 offset:0
    ds_read_b32 v11, v22 offset:512
    ds_read_b32 v12, v22 offset:1024
    ds_read_b32 v13, v22 offset:1536
    ds_read_b32 v112, v21 offset:2048
    ds_read_b32 v113, v21 offset:2816
    ds_read_b32 v114, v21 offset:3584
    ds_read_b32 v115, v21 offset:4352
    ds_read_b32 v116, v21 offset:2304
    ds_read_b32 v117, v21 offset:3072
    ds_read_b32 v118, v21 offset:3840
    ds_read_b32 v119, v21 offset:4608
    ds_read_b32 v120, v21 offset:2560
    ds_read_b32 v121, v21 offset:3328
    ds_read_b32 v122, v21 offset:4096
    ds_read_b32 v123, v21 offset:4864
    v_mov_b32 v135, 0
    v_lshl_or_b32 v134, v28, 16, v28
    v_mov_b32 v139, 0
    v_lshl_or_b32 v138, v29, 16, v29
    v_mov_b32 v143, 0
    v_lshl_or_b32 v142, v30, 16, v30
    v_cmp_gt_u32 vcc, 32, v1
    v_mov_b32 v131, 0
    s_waitcnt lgkmcnt(12)
    v_add_f32 v10, v10, v11
    v_add_f32 v12, v12, v13
    v_mul_f32 v10, 0xbb000000, v10
    v_mul_f32 v11, v10, v10
    v_mov_b32 v13, 0x3b000000
    v_fma_f32 v12, v12, v13, -v11
    v_max_f32 v12, 0, v12
    v_add_f32 v11, 0x3727c5ac, v12
    v_rsq_f32 v11, v11
    v_cvt_pk_bf16_f32 v13, v10, v10
    v_lshlrev_b32 v13, 16, v13
    v_sub_f32 v13, v10, v13
    v_cvt_pk_bf16_f32 v13, v10, v13
    v_cndmask_b32 v128, 0, v13, vcc
    v_mov_b32 v129, v128
    v_mul_f32 v13, v11, v11
    v_fmaak_f32 v13, v13, v12, 0x3727c5ac
    v_rsq_f32 v13, v13
    s_nop 0
    v_mul_f32 v11, v11, v13
    v_rcp_f32 v12, v11
    s_nop 0
    v_cvt_pk_bf16_f32 v13, v12, v12
    v_lshlrev_b32 v13, 16, v13
    v_sub_f32 v13, v12, v13
    v_cvt_pk_bf16_f32 v13, v12, v13
    v_cndmask_b32 v130, 0, v13, vcc
    s_waitcnt lgkmcnt(0)
    v_add_f32 v112, v112, v113
    v_add_f32 v114, v114, v115
    v_add_f32 v112, v112, v114
    v_cvt_pk_bf16_f32 v132, v112, v112
    v_lshlrev_b32 v113, 16, v132
    v_sub_f32 v112, v112, v113
    v_cvt_pk_bf16_f32 v133, v112, v112
    s_nop 1
    v_mfma_f32_32x32x16_bf16 v[64:79], v[132:135], v[128:131], v[64:79]
    v_add_f32 v116, v116, v117
    v_add_f32 v118, v118, v119
    v_add_f32 v116, v116, v118
    v_cvt_pk_bf16_f32 v136, v116, v116
    v_lshlrev_b32 v117, 16, v136
    v_sub_f32 v116, v116, v117
    v_cvt_pk_bf16_f32 v137, v116, v116
    s_nop 1
    v_mfma_f32_32x32x16_bf16 v[80:95], v[136:139], v[128:131], v[80:95]
    v_add_f32 v120, v120, v121
    v_add_f32 v122, v122, v123
    v_add_f32 v120, v120, v122
    v_cvt_pk_bf16_f32 v140, v120, v120
    v_lshlrev_b32 v121, 16, v140
    v_sub_f32 v120, v120, v121
    v_cvt_pk_bf16_f32 v141, v120, v120
    s_nop 1
    v_mfma_f32_32x32x16_bf16 v[96:111], v[140:143], v[128:131], v[96:111]
    s_lshl_b32 s47, s20, 2
    s_add_u32 s47, s47, s23
    s_mul_i32 s47, s47, 43
    s_mul_i32 s56, s49, 6
    s_add_u32 s56, s56, s24
    s_add_u32 s47, s47, s56
    s_lshl_b32 s57, s47, 11
    v_lshlrev_b32 v25, 4, v1
    v_mov_b32 v13, 0xbdd2d3e8
    v_mov_b32 v12, 0xc0135761
    v_mov_b32 v14, 1.0
    s_cmp_ge_u32 s56, 43
    s_cbranch_scc1 H_END
    v_pk_mul_f32 v[64:65], v[64:65], v[10:11] op_sel:[0,1]
    v_pk_mul_f32 v[66:67], v[66:67], v[10:11] op_sel:[0,1]
    v_pk_mul_f32 v[68:69], v[68:69], v[10:11] op_sel:[0,1]
    v_pk_mul_f32 v[70:71], v[70:71], v[10:11] op_sel:[0,1]
    v_pk_mul_f32 v[144:145], v[64:65], v[64:65]
    v_pk_mul_f32 v[146:147], v[66:67], v[66:67]
    v_pk_mul_f32 v[148:149], v[68:69], v[68:69]
    v_pk_mul_f32 v[150:151], v[70:71], v[70:71]
    v_pk_fma_f32 v[144:145], v[144:145], v[12:13], v[12:13] op_sel:[0,1,0] op_sel_hi:[1,1,0]
    v_pk_fma_f32 v[146:147], v[146:147], v[12:13], v[12:13] op_sel:[0,1,0] op_sel_hi:[1,1,0]
    v_pk_fma_f32 v[148:149], v[148:149], v[12:13], v[12:13] op_sel:[0,1,0] op_sel_hi:[1,1,0]
    v_pk_fma_f32 v[150:151], v[150:151], v[12:13], v[12:13] op_sel:[0,1,0] op_sel_hi:[1,1,0]
    v_pk_mul_f32 v[144:145], v[144:145], v[64:65]
    v_pk_mul_f32 v[146:147], v[146:147], v[66:67]
    v_pk_mul_f32 v[148:149], v[148:149], v[68:69]
    v_pk_mul_f32 v[150:151], v[150:151], v[70:71]
    v_exp_f32 v144, v144
    v_exp_f32 v145, v145
    v_exp_f32 v146, v146
    v_exp_f32 v147, v147
    v_exp_f32 v148, v148
    v_exp_f32 v149, v149
    v_exp_f32 v150, v150
    v_exp_f32 v151, v151
    v_pk_add_f32 v[144:145], v[144:145], v[14:15] op_sel_hi:[1,0]
    v_pk_add_f32 v[146:147], v[146:147], v[14:15] op_sel_hi:[1,0]
    v_pk_add_f32 v[148:149], v[148:149], v[14:15] op_sel_hi:[1,0]
    v_pk_add_f32 v[150:151], v[150:151], v[14:15] op_sel_hi:[1,0]
    v_rcp_f32 v144, v144
    v_rcp_f32 v145, v145
    v_rcp_f32 v146, v146
    v_rcp_f32 v147, v147
    v_rcp_f32 v148, v148
    v_rcp_f32 v149, v149
    v_rcp_f32 v150, v150
    v_rcp_f32 v151, v151
    v_pk_mul_f32 v[64:65], v[64:65], v[144:145]
    v_pk_mul_f32 v[66:67], v[66:67], v[146:147]
    v_pk_mul_f32 v[68:69], v[68:69], v[148:149]
    v_pk_mul_f32 v[70:71], v[70:71], v[150:151]
    v_cvt_pk_bf16_f32 v40, v64, v65
    v_cvt_pk_bf16_f32 v41, v66, v67
    v_cvt_pk_bf16_f32 v42, v68, v69
    v_cvt_pk_bf16_f32 v43, v70, v71
    buffer_store_dwordx4 v[40:43], v25, s[12:15], s57 offen offset:0 sc1
    v_pk_mul_f32 v[72:73], v[72:73], v[10:11] op_sel:[0,1]
    v_pk_mul_f32 v[74:75], v[74:75], v[10:11] op_sel:[0,1]
    v_pk_mul_f32 v[76:77], v[76:77], v[10:11] op_sel:[0,1]
    v_pk_mul_f32 v[78:79], v[78:79], v[10:11] op_sel:[0,1]
    v_pk_mul_f32 v[152:153], v[72:73], v[72:73]
    v_pk_mul_f32 v[154:155], v[74:75], v[74:75]
    v_pk_mul_f32 v[156:157], v[76:77], v[76:77]
    v_pk_mul_f32 v[158:159], v[78:79], v[78:79]
    v_pk_fma_f32 v[152:153], v[152:153], v[12:13], v[12:13] op_sel:[0,1,0] op_sel_hi:[1,1,0]
    v_pk_fma_f32 v[154:155], v[154:155], v[12:13], v[12:13] op_sel:[0,1,0] op_sel_hi:[1,1,0]
    v_pk_fma_f32 v[156:157], v[156:157], v[12:13], v[12:13] op_sel:[0,1,0] op_sel_hi:[1,1,0]
    v_pk_fma_f32 v[158:159], v[158:159], v[12:13], v[12:13] op_sel:[0,1,0] op_sel_hi:[1,1,0]
    v_pk_mul_f32 v[152:153], v[152:153], v[72:73]
    v_pk_mul_f32 v[154:155], v[154:155], v[74:75]
    v_pk_mul_f32 v[156:157], v[156:157], v[76:77]
    v_pk_mul_f32 v[158:159], v[158:159], v[78:79]
    v_exp_f32 v152, v152
    v_exp_f32 v153, v153
    v_exp_f32 v154, v154
    v_exp_f32 v155, v155
    v_exp_f32 v156, v156
    v_exp_f32 v157, v157
    v_exp_f32 v158, v158
    v_exp_f32 v159, v159
    v_pk_add_f32 v[152:153], v[152:153], v[14:15] op_sel_hi:[1,0]
    v_pk_add_f32 v[154:155], v[154:155], v[14:15] op_sel_hi:[1,0]
    v_pk_add_f32 v[156:157], v[156:157], v[14:15] op_sel_hi:[1,0]
    v_pk_add_f32 v[158:159], v[158:159], v[14:15] op_sel_hi:[1,0]
    v_rcp_f32 v152, v152
    v_rcp_f32 v153, v153
    v_rcp_f32 v154, v154
    v_rcp_f32 v155, v155
    v_rcp_f32 v156, v156
    v_rcp_f32 v157, v157
    v_rcp_f32 v158, v158
    v_rcp_f32 v159, v159
    v_pk_mul_f32 v[72:73], v[72:73], v[152:153]
    v_pk_mul_f32 v[74:75], v[74:75], v[154:155]
    v_pk_mul_f32 v[76:77], v[76:77], v[156:157]
    v_pk_mul_f32 v[78:79], v[78:79], v[158:159]
    v_cvt_pk_bf16_f32 v44, v72, v73
    v_cvt_pk_bf16_f32 v45, v74, v75
    v_cvt_pk_bf16_f32 v46, v76, v77
    v_cvt_pk_bf16_f32 v47, v78, v79
    buffer_store_dwordx4 v[44:47], v25, s[12:15], s57 offen offset:1024 sc1
    s_nop 1
    s_add_u32 s57, s57, 4096
    s_cmp_ge_u32 s56, 41
    s_cbranch_scc1 H_END
    v_pk_mul_f32 v[80:81], v[80:81], v[10:11] op_sel:[0,1]
    v_pk_mul_f32 v[82:83], v[82:83], v[10:11] op_sel:[0,1]
    v_pk_mul_f32 v[84:85], v[84:85], v[10:11] op_sel:[0,1]
    v_pk_mul_f32 v[86:87], v[86:87], v[10:11] op_sel:[0,1]
    v_pk_mul_f32 v[160:161], v[80:81], v[80:81]
    v_pk_mul_f32 v[162:163], v[82:83], v[82:83]
    v_pk_mul_f32 v[164:165], v[84:85], v[84:85]
    v_pk_mul_f32 v[166:167], v[86:87], v[86:87]
    v_pk_fma_f32 v[160:161], v[160:161], v[12:13], v[12:13] op_sel:[0,1,0] op_sel_hi:[1,1,0]
    v_pk_fma_f32 v[162:163], v[162:163], v[12:13], v[12:13] op_sel:[0,1,0] op_sel_hi:[1,1,0]
    v_pk_fma_f32 v[164:165], v[164:165], v[12:13], v[12:13] op_sel:[0,1,0] op_sel_hi:[1,1,0]
    v_pk_fma_f32 v[166:167], v[166:167], v[12:13], v[12:13] op_sel:[0,1,0] op_sel_hi:[1,1,0]
    v_pk_mul_f32 v[160:161], v[160:161], v[80:81]
    v_pk_mul_f32 v[162:163], v[162:163], v[82:83]
    v_pk_mul_f32 v[164:165], v[164:165], v[84:85]
    v_pk_mul_f32 v[166:167], v[166:167], v[86:87]
    v_exp_f32 v160, v160
    v_exp_f32 v161, v161
    v_exp_f32 v162, v162
    v_exp_f32 v163, v163
    v_exp_f32 v164, v164
    v_exp_f32 v165, v165
    v_exp_f32 v166, v166
    v_exp_f32 v167, v167
    v_pk_add_f32 v[160:161], v[160:161], v[14:15] op_sel_hi:[1,0]
    v_pk_add_f32 v[162:163], v[162:163], v[14:15] op_sel_hi:[1,0]
    v_pk_add_f32 v[164:165], v[164:165], v[14:15] op_sel_hi:[1,0]
    v_pk_add_f32 v[166:167], v[166:167], v[14:15] op_sel_hi:[1,0]
    v_rcp_f32 v160, v160
    v_rcp_f32 v161, v161
    v_rcp_f32 v162, v162
    v_rcp_f32 v163, v163
    v_rcp_f32 v164, v164
    v_rcp_f32 v165, v165
    v_rcp_f32 v166, v166
    v_rcp_f32 v167, v167
    v_pk_mul_f32 v[80:81], v[80:81], v[160:161]
    v_pk_mul_f32 v[82:83], v[82:83], v[162:163]
    v_pk_mul_f32 v[84:85], v[84:85], v[164:165]
    v_pk_mul_f32 v[86:87], v[86:87], v[166:167]
    v_cvt_pk_bf16_f32 v48, v80, v81
    v_cvt_pk_bf16_f32 v49, v82, v83
    v_cvt_pk_bf16_f32 v50, v84, v85
    v_cvt_pk_bf16_f32 v51, v86, v87
    buffer_store_dwordx4 v[48:51], v25, s[12:15], s57 offen offset:0 sc1
    v_pk_mul_f32 v[88:89], v[88:89], v[10:11] op_sel:[0,1]
    v_pk_mul_f32 v[90:91], v[90:91], v[10:11] op_sel:[0,1]
    v_pk_mul_f32 v[92:93], v[92:93], v[10:11] op_sel:[0,1]
    v_pk_mul_f32 v[94:95], v[94:95], v[10:11] op_sel:[0,1]
    v_pk_mul_f32 v[168:169], v[88:89], v[88:89]
    v_pk_mul_f32 v[170:171], v[90:91], v[90:91]
    v_pk_mul_f32 v[172:173], v[92:93], v[92:93]
    v_pk_mul_f32 v[174:175], v[94:95], v[94:95]
    v_pk_fma_f32 v[168:169], v[168:169], v[12:13], v[12:13] op_sel:[0,1,0] op_sel_hi:[1,1,0]
    v_pk_fma_f32 v[170:171], v[170:171], v[12:13], v[12:13] op_sel:[0,1,0] op_sel_hi:[1,1,0]
    v_pk_fma_f32 v[172:173], v[172:173], v[12:13], v[12:13] op_sel:[0,1,0] op_sel_hi:[1,1,0]
    v_pk_fma_f32 v[174:175], v[174:175], v[12:13], v[12:13] op_sel:[0,1,0] op_sel_hi:[1,1,0]
    v_pk_mul_f32 v[168:169], v[168:169], v[88:89]
    v_pk_mul_f32 v[170:171], v[170:171], v[90:91]
    v_pk_mul_f32 v[172:173], v[172:173], v[92:93]
    v_pk_mul_f32 v[174:175], v[174:175], v[94:95]
    v_exp_f32 v168, v168
    v_exp_f32 v169, v169
    v_exp_f32 v170, v170
    v_exp_f32 v171, v171
    v_exp_f32 v172, v172
    v_exp_f32 v173, v173
    v_exp_f32 v174, v174
    v_exp_f32 v175, v175
    v_pk_add_f32 v[168:169], v[168:169], v[14:15] op_sel_hi:[1,0]
    v_pk_add_f32 v[170:171], v[170:171], v[14:15] op_sel_hi:[1,0]
    v_pk_add_f32 v[172:173], v[172:173], v[14:15] op_sel_hi:[1,0]
    v_pk_add_f32 v[174:175], v[174:175], v[14:15] op_sel_hi:[1,0]
    v_rcp_f32 v168, v168
    v_rcp_f32 v169, v169
    v_rcp_f32 v170, v170
    v_rcp_f32 v171, v171
    v_rcp_f32 v172, v172
    v_rcp_f32 v173, v173
    v_rcp_f32 v174, v174
    v_rcp_f32 v175, v175
    v_pk_mul_f32 v[88:89], v[88:89], v[168:169]
    v_pk_mul_f32 v[90:91], v[90:91], v[170:171]
    v_pk_mul_f32 v[92:93], v[92:93], v[172:173]
    v_pk_mul_f32 v[94:95], v[94:95], v[174:175]
    v_cvt_pk_bf16_f32 v52, v88, v89
    v_cvt_pk_bf16_f32 v53, v90, v91
    v_cvt_pk_bf16_f32 v54, v92, v93
    v_cvt_pk_bf16_f32 v55, v94, v95
    buffer_store_dwordx4 v[52:55], v25, s[12:15], s57 offen offset:1024 sc1
    s_nop 1
    s_add_u32 s57, s57, 4096
    s_cmp_ge_u32 s56, 39
    s_cbranch_scc1 H_END
    v_pk_mul_f32 v[96:97], v[96:97], v[10:11] op_sel:[0,1]
    v_pk_mul_f32 v[98:99], v[98:99], v[10:11] op_sel:[0,1]
    v_pk_mul_f32 v[100:101], v[100:101], v[10:11] op_sel:[0,1]
    v_pk_mul_f32 v[102:103], v[102:103], v[10:11] op_sel:[0,1]
    v_pk_mul_f32 v[144:145], v[96:97], v[96:97]
    v_pk_mul_f32 v[146:147], v[98:99], v[98:99]
    v_pk_mul_f32 v[148:149], v[100:101], v[100:101]
    v_pk_mul_f32 v[150:151], v[102:103], v[102:103]
    v_pk_fma_f32 v[144:145], v[144:145], v[12:13], v[12:13] op_sel:[0,1,0] op_sel_hi:[1,1,0]
    v_pk_fma_f32 v[146:147], v[146:147], v[12:13], v[12:13] op_sel:[0,1,0] op_sel_hi:[1,1,0]
    v_pk_fma_f32 v[148:149], v[148:149], v[12:13], v[12:13] op_sel:[0,1,0] op_sel_hi:[1,1,0]
    v_pk_fma_f32 v[150:151], v[150:151], v[12:13], v[12:13] op_sel:[0,1,0] op_sel_hi:[1,1,0]
    v_pk_mul_f32 v[144:145], v[144:145], v[96:97]
    v_pk_mul_f32 v[146:147], v[146:147], v[98:99]
    v_pk_mul_f32 v[148:149], v[148:149], v[100:101]
    v_pk_mul_f32 v[150:151], v[150:151], v[102:103]
    v_exp_f32 v144, v144
    v_exp_f32 v145, v145
    v_exp_f32 v146, v146
    v_exp_f32 v147, v147
    v_exp_f32 v148, v148
    v_exp_f32 v149, v149
    v_exp_f32 v150, v150
    v_exp_f32 v151, v151
    v_pk_add_f32 v[144:145], v[144:145], v[14:15] op_sel_hi:[1,0]
    v_pk_add_f32 v[146:147], v[146:147], v[14:15] op_sel_hi:[1,0]
    v_pk_add_f32 v[148:149], v[148:149], v[14:15] op_sel_hi:[1,0]
    v_pk_add_f32 v[150:151], v[150:151], v[14:15] op_sel_hi:[1,0]
    v_rcp_f32 v144, v144
    v_rcp_f32 v145, v145
    v_rcp_f32 v146, v146
    v_rcp_f32 v147, v147
    v_rcp_f32 v148, v148
    v_rcp_f32 v149, v149
    v_rcp_f32 v150, v150
    v_rcp_f32 v151, v151
    v_pk_mul_f32 v[96:97], v[96:97], v[144:145]
    v_pk_mul_f32 v[98:99], v[98:99], v[146:147]
    v_pk_mul_f32 v[100:101], v[100:101], v[148:149]
    v_pk_mul_f32 v[102:103], v[102:103], v[150:151]
    v_cvt_pk_bf16_f32 v56, v96, v97
    v_cvt_pk_bf16_f32 v57, v98, v99
    v_cvt_pk_bf16_f32 v58, v100, v101
    v_cvt_pk_bf16_f32 v59, v102, v103
    buffer_store_dwordx4 v[56:59], v25, s[12:15], s57 offen offset:0 sc1
    v_pk_mul_f32 v[104:105], v[104:105], v[10:11] op_sel:[0,1]
    v_pk_mul_f32 v[106:107], v[106:107], v[10:11] op_sel:[0,1]
    v_pk_mul_f32 v[108:109], v[108:109], v[10:11] op_sel:[0,1]
    v_pk_mul_f32 v[110:111], v[110:111], v[10:11] op_sel:[0,1]
    v_pk_mul_f32 v[152:153], v[104:105], v[104:105]
    v_pk_mul_f32 v[154:155], v[106:107], v[106:107]
    v_pk_mul_f32 v[156:157], v[108:109], v[108:109]
    v_pk_mul_f32 v[158:159], v[110:111], v[110:111]
    v_pk_fma_f32 v[152:153], v[152:153], v[12:13], v[12:13] op_sel:[0,1,0] op_sel_hi:[1,1,0]
    v_pk_fma_f32 v[154:155], v[154:155], v[12:13], v[12:13] op_sel:[0,1,0] op_sel_hi:[1,1,0]
    v_pk_fma_f32 v[156:157], v[156:157], v[12:13], v[12:13] op_sel:[0,1,0] op_sel_hi:[1,1,0]
    v_pk_fma_f32 v[158:159], v[158:159], v[12:13], v[12:13] op_sel:[0,1,0] op_sel_hi:[1,1,0]
    v_pk_mul_f32 v[152:153], v[152:153], v[104:105]
    v_pk_mul_f32 v[154:155], v[154:155], v[106:107]
    v_pk_mul_f32 v[156:157], v[156:157], v[108:109]
    v_pk_mul_f32 v[158:159], v[158:159], v[110:111]
    v_exp_f32 v152, v152
    v_exp_f32 v153, v153
    v_exp_f32 v154, v154
    v_exp_f32 v155, v155
    v_exp_f32 v156, v156
    v_exp_f32 v157, v157
    v_exp_f32 v158, v158
    v_exp_f32 v159, v159
    v_pk_add_f32 v[152:153], v[152:153], v[14:15] op_sel_hi:[1,0]
    v_pk_add_f32 v[154:155], v[154:155], v[14:15] op_sel_hi:[1,0]
    v_pk_add_f32 v[156:157], v[156:157], v[14:15] op_sel_hi:[1,0]
    v_pk_add_f32 v[158:159], v[158:159], v[14:15] op_sel_hi:[1,0]
    v_rcp_f32 v152, v152
    v_rcp_f32 v153, v153
    v_rcp_f32 v154, v154
    v_rcp_f32 v155, v155
    v_rcp_f32 v156, v156
    v_rcp_f32 v157, v157
    v_rcp_f32 v158, v158
    v_rcp_f32 v159, v159
    v_pk_mul_f32 v[104:105], v[104:105], v[152:153]
    v_pk_mul_f32 v[106:107], v[106:107], v[154:155]
    v_pk_mul_f32 v[108:109], v[108:109], v[156:157]
    v_pk_mul_f32 v[110:111], v[110:111], v[158:159]
    v_cvt_pk_bf16_f32 v60, v104, v105
    v_cvt_pk_bf16_f32 v61, v106, v107
    v_cvt_pk_bf16_f32 v62, v108, v109
    v_cvt_pk_bf16_f32 v63, v110, v111
    buffer_store_dwordx4 v[60:63], v25, s[12:15], s57 offen offset:1024 sc1
    s_nop 1
    s_add_u32 s57, s57, 4096
H_END:
K1_END:
    s_endpgm
.globl k2_kernel
.p2align 8
.type k2_kernel,@function
k2_kernel:
    s_cmp_ge_u32 s2, 256
    s_cbranch_scc1 K2_END
    s_load_dwordx2 s[36:37], s[0:1], 0
    s_load_dwordx2 s[38:39], s[0:1], 24
    s_load_dwordx4 s[40:43], s[0:1], 56
    s_load_dwordx4 s[44:47], s[0:1], 72
    s_load_dwordx2 s[48:49], s[0:1], 88
    v_lshrrev_b32 v2, 6, v0
    v_and_b32 v1, 63, v0
    v_readfirstlane_b32 s50, v2
    s_and_b32 s51, s2, 7
    s_lshr_b32 s52, s2, 3
    s_lshl_b32 s51, s51, 2
    s_lshr_b32 s53, s52, 3
    s_add_u32 s51, s51, s53
    s_and_b32 s52, s52, 7
    s_lshr_b32 s53, s50, 1
    s_and_b32 s54, s50, 1
    v_lshlrev_b32 v2, 4, v1
    s_mul_i32 s55, s54, 88064
    v_add_u32 v3, s55, v2
    s_sub_u32 s55, 88064, s55
    v_add_u32 v4, s55, v2
    s_lshl_b32 s55, s54, 16
    v_add_u32 v5, s55, v2
    s_sub_u32 s55, 0x10000, s55
    v_add_u32 v6, s55, v2
    s_mul_i32 s56, s51, 176128
    s_mul_i32 s55, s50, 22528
    s_add_u32 s56, s56, s55
    s_lshl_b32 s57, s51, 17
    s_lshl_b32 s55, s50, 14
    s_add_u32 s57, s57, s55
    s_add_u32 s57, s57, 6291456
    v_lshrrev_b32 v8, 3, v1
    v_bfe_u32 v9, v1, 4, 1
    v_lshlrev_b32 v9, 2, v9
    v_and_b32 v10, 7, v1
    v_xor_b32 v9, v9, v10
    v_lshlrev_b32 v9, 4, v9
    v_lshl_add_u32 v7, v8, 10, v9
    s_lshl_b32 s55, s52, 7
    v_add_u32 v7, s55, v7
    s_mul_i32 s58, s50, 360448
    s_lshl_b32 s59, s50, 17
    s_mul_i32 s61, s50, 28672
    v_lshrrev_b32 v14, 4, v1
    v_and_b32 v15, 15, v1
    v_lshlrev_b32 v15, 4, v15
    v_lshl_add_u32 v16, v14, 14, v15
    v_lshl_add_u32 v15, v14, 2, v15
    s_waitcnt lgkmcnt(0)
    s_mov_b32 s4, s40
    s_mov_b32 s5, s41
    s_mov_b32 s6, 1409024
    s_mov_b32 s7, 0x20000
    s_mov_b32 s12, s48
    s_mov_b32 s13, s49
    s_mov_b32 s14, 50331648
    s_mov_b32 s15, 0x20000
    s_mov_b32 s16, s48
    s_mov_b32 s17, s49
    s_mov_b32 s18, 5636096
    s_mov_b32 s19, 0x20000
    s_cmp_lg_u32 s50, 3
    s_cbranch_scc1 K2_NR1
    s_lshr_b32 s55, s2, 3
    s_lshl_b32 s55, s55, 16
    s_bfe_u32 s63, s2, 0x10002
    s_lshl_b32 s63, s63, 11
    s_add_u32 s55, s55, s63
    s_and_b32 s63, s2, 3
    s_lshl_b32 s63, s63, 8
    s_add_u32 s55, s55, s63
    s_add_u32 s55, s55, 10485760
    buffer_load_dwordx4 v[64:67], v16, s[12:15], s55 offen offset:0
    buffer_load_dwordx4 v[68:71], v16, s[12:15], s55 offen offset:1024
    s_add_u32 s55, s55, 4096
    buffer_load_dwordx4 v[72:75], v16, s[12:15], s55 offen offset:0
    buffer_load_dwordx4 v[76:79], v16, s[12:15], s55 offen offset:1024
    s_add_u32 s55, s55, 4096
    buffer_load_dwordx4 v[80:83], v16, s[12:15], s55 offen offset:0
    buffer_load_dwordx4 v[84:87], v16, s[12:15], s55 offen offset:1024
    s_add_u32 s55, s55, 4096
    buffer_load_dwordx4 v[88:91], v16, s[12:15], s55 offen offset:0
    buffer_load_dwordx4 v[92:95], v16, s[12:15], s55 offen offset:1024
    s_add_u32 s55, s55, 4096
K2_NR1:
    buffer_load_dwordx4 a[0:3], v3, s[16:19], s56 offen offset:0
    buffer_load_dwordx4 a[4:7], v3, s[16:19], s56 offen offset:1024
    buffer_load_dwordx4 a[8:11], v4, s[16:19], s56 offen offset:0
    buffer_load_dwordx4 a[12:15], v4, s[16:19], s56 offen offset:1024
    s_add_u32 s56, s56, 2048
    s_add_u32 m0, s61, 0
    s_nop 0
    buffer_load_dwordx4 v7, s[4:7], s58 offen lds
    s_add_u32 s58, s58, 8192
    s_add_u32 m0, s61, 1024
    s_nop 0
    buffer_load_dwordx4 v7, s[4:7], s58 offen lds
    s_add_u32 s58, s58, 8192
    s_add_u32 m0, s61, 2048
    s_nop 0
    buffer_load_dwordx4 v7, s[4:7], s58 offen lds
    s_add_u32 s58, s58, 8192
    s_add_u32 m0, s61, 3072
    s_nop 0
    buffer_load_dwordx4 v7, s[4:7], s58 offen lds
    s_add_u32 s58, s58, 8192
    buffer_load_dwordx4 a[16:19], v3, s[16:19], s56 offen offset:0
    buffer_load_dwordx4 a[20:23], v3, s[16:19], s56 offen offset:1024
    buffer_load_dwordx4 a[24:27], v4, s[16:19], s56 offen offset:0
    buffer_load_dwordx4 a[28:31], v4, s[16:19], s56 offen offset:1024
    s_add_u32 s56, s56, 2048
    s_add_u32 m0, s61, 4096
    s_nop 0
    buffer_load_dwordx4 v7, s[4:7], s58 offen lds
    s_add_u32 s58, s58, 8192
    s_add_u32 m0, s61, 5120
    s_nop 0
    buffer_load_dwordx4 v7, s[4:7], s58 offen lds
    s_add_u32 s58, s58, 8192
    s_add_u32 m0, s61, 6144
    s_nop 0
    buffer_load_dwordx4 v7, s[4:7], s58 offen lds
    s_add_u32 s58, s58, 8192
    s_add_u32 m0, s61, 7168
    s_nop 0
    buffer_load_dwordx4 v7, s[4:7], s58 offen lds
    s_add_u32 s58, s58, 8192
    buffer_load_dwordx4 a[32:35], v3, s[16:19], s56 offen offset:0
    buffer_load_dwordx4 a[36:39], v3, s[16:19], s56 offen offset:1024
    buffer_load_dwordx4 a[40:43], v4, s[16:19], s56 offen offset:0
    buffer_load_dwordx4 a[44:47], v4, s[16:19], s56 offen offset:1024
    s_add_u32 s56, s56, 2048
    s_add_u32 m0, s61, 8192
    s_nop 0
    buffer_load_dwordx4 v7, s[4:7], s58 offen lds
    s_add_u32 s58, s58, 8192
    s_add_u32 m0, s61, 9216
    s_nop 0
    buffer_load_dwordx4 v7, s[4:7], s58 offen lds
    s_add_u32 s58, s58, 8192
    s_add_u32 m0, s61, 10240
    s_nop 0
    buffer_load_dwordx4 v7, s[4:7], s58 offen lds
    s_add_u32 s58, s58, 8192
    s_add_u32 m0, s61, 11264
    s_nop 0
    buffer_load_dwordx4 v7, s[4:7], s58 offen lds
    s_add_u32 s58, s58, 8192
    buffer_load_dwordx4 a[48:51], v3, s[16:19], s56 offen offset:0
    buffer_load_dwordx4 a[52:55], v3, s[16:19], s56 offen offset:1024
    buffer_load_dwordx4 a[56:59], v4, s[16:19], s56 offen offset:0
    buffer_load_dwordx4 a[60:63], v4, s[16:19], s56 offen offset:1024
    s_add_u32 s56, s56, 2048
    s_add_u32 m0, s61, 12288
    s_nop 0
    buffer_load_dwordx4 v7, s[4:7], s58 offen lds
    s_add_u32 s58, s58, 8192
    s_add_u32 m0, s61, 13312
    s_nop 0
    buffer_load_dwordx4 v7, s[4:7], s58 offen lds
    s_add_u32 s58, s58, 8192
    s_add_u32 m0, s61, 14336
    s_nop 0
    buffer_load_dwordx4 v7, s[4:7], s58 offen lds
    s_add_u32 s58, s58, 8192
    s_add_u32 m0, s61, 15360
    s_nop 0
    buffer_load_dwordx4 v7, s[4:7], s58 offen lds
    s_add_u32 s58, s58, 8192
    buffer_load_dwordx4 a[64:67], v3, s[16:19], s56 offen offset:0
    buffer_load_dwordx4 a[68:71], v3, s[16:19], s56 offen offset:1024
    buffer_load_dwordx4 a[72:75], v4, s[16:19], s56 offen offset:0
    buffer_load_dwordx4 a[76:79], v4, s[16:19], s56 offen offset:1024
    s_add_u32 s56, s56, 2048
    s_add_u32 m0, s61, 16384
    s_nop 0
    buffer_load_dwordx4 v7, s[4:7], s58 offen lds
    s_add_u32 s58, s58, 8192
    s_add_u32 m0, s61, 17408
    s_nop 0
    buffer_load_dwordx4 v7, s[4:7], s58 offen lds
    s_add_u32 s58, s58, 8192
    s_add_u32 m0, s61, 18432
    s_nop 0
    buffer_load_dwordx4 v7, s[4:7], s58 offen lds
    s_add_u32 s58, s58, 8192
    s_add_u32 m0, s61, 19456
    s_nop 0
    buffer_load_dwordx4 v7, s[4:7], s58 offen lds
    s_add_u32 s58, s58, 8192
    buffer_load_dwordx4 a[80:83], v3, s[16:19], s56 offen offset:0
    buffer_load_dwordx4 a[84:87], v3, s[16:19], s56 offen offset:1024
    buffer_load_dwordx4 a[88:91], v4, s[16:19], s56 offen offset:0
    buffer_load_dwordx4 a[92:95], v4, s[16:19], s56 offen offset:1024
    s_add_u32 s56, s56, 2048
    s_add_u32 m0, s61, 20480
    s_nop 0
    buffer_load_dwordx4 v7, s[4:7], s58 offen lds
    s_add_u32 s58, s58, 8192
    s_add_u32 m0, s61, 21504
    s_nop 0
    buffer_load_dwordx4 v7, s[4:7], s58 offen lds
    s_add_u32 s58, s58, 8192
    s_add_u32 m0, s61, 22528
    s_nop 0
    buffer_load_dwordx4 v7, s[4:7], s58 offen lds
    s_add_u32 s58, s58, 8192
    s_add_u32 m0, s61, 23552
    s_nop 0
    buffer_load_dwordx4 v7, s[4:7], s58 offen lds
    s_add_u32 s58, s58, 8192
    s_cmp_lg_u32 s50, 3
    s_cbranch_scc1 K2_NR2
    s_waitcnt vmcnt(48)
    v_pk_add_f32 v[64:65], v[64:65], v[72:73]
    v_pk_add_f32 v[80:81], v[80:81], v[88:89]
    v_pk_add_f32 v[66:67], v[66:67], v[74:75]
    v_pk_add_f32 v[82:83], v[82:83], v[90:91]
    v_pk_add_f32 v[68:69], v[68:69], v[76:77]
    v_pk_add_f32 v[84:85], v[84:85], v[92:93]
    v_pk_add_f32 v[70:71], v[70:71], v[78:79]
    v_pk_add_f32 v[86:87], v[86:87], v[94:95]
    v_pk_add_f32 v[64:65], v[64:65], v[80:81]
    v_pk_add_f32 v[66:67], v[66:67], v[82:83]
    v_pk_add_f32 v[68:69], v[68:69], v[84:85]
    v_pk_add_f32 v[70:71], v[70:71], v[86:87]
    s_nop 0
s_nop 1
    v_permlane32_swap_b32 v64, v68
s_nop 1
    v_permlane32_swap_b32 v65, v69
s_nop 1
    v_permlane32_swap_b32 v66, v70
s_nop 1
    v_permlane32_swap_b32 v67, v71
    v_pk_add_f32 v[64:65], v[64:65], v[68:69]
    v_pk_add_f32 v[66:67], v[66:67], v[70:71]
    s_nop 1
    v_permlane16_swap_b32 v64, v66
s_nop 1
    v_permlane16_swap_b32 v65, v67
    v_pk_add_f32 v[64:65], v[64:65], v[66:67]
    v_cvt_pk_bf16_f32 v72, v64, v65
    s_lshl_b32 s55, s2, 8
    s_add_u32 s55, s55, 12582912
s_waitcnt vmcnt(0)
    buffer_store_dword v72, v15, s[12:15], s55 offen sc1
K2_NR2:
    s_mov_b32 s8, s38
    s_mov_b32 s9, s39
    s_mov_b32 s10, 524288
    s_mov_b32 s11, 0x20000
    s_mov_b32 s20, s36
    s_mov_b32 s21, s37
    s_mov_b32 s22, 2097152
    s_mov_b32 s23, 0x20000
    s_mov_b32 s24, s44
    s_mov_b32 s25, s45
    s_mov_b32 s26, 2097152
    s_mov_b32 s27, 0x20000
    s_mov_b32 s28, s42
    s_mov_b32 s29, s43
    s_mov_b32 s30, 1024
    s_mov_b32 s31, 0x20000
    v_lshrrev_b32 v12, 5, v1
    v_bfe_u32 v8, v1, 2, 2
    v_lshl_add_u32 v8, v12, 2, v8
    v_lshlrev_b32 v8, 7, v8
    v_and_b32 v9, 1, v1
    v_lshl_add_u32 v8, v9, 3, v8
    v_add_u32 v8, s61, v8
    v_bfe_u32 v9, v1, 4, 1
    v_bfe_u32 v10, v1, 1, 1
    v_lshl_add_u32 v9, v9, 1, v10
    v_bfe_u32 v10, v1, 3, 1
    v_xor_b32 v10, s53, v10
    v_lshl_add_u32 v9, v10, 2, v9
    v_lshlrev_b32 v10, 4, v9
    v_xor_b32 v9, 64, v10
    v_add_u32 v9, v9, v8
    v_add_u32 v8, v10, v8
    s_lshl_b32 s55, s51, 1
    s_add_u32 s55, s55, s54
    s_lshl_b32 s55, s55, 15
    v_and_b32 v11, 31, v1
    v_lshlrev_b32 v11, 10, v11
    v_add_u32 v11, s55, v11
    s_lshl_b32 s55, s52, 7
    s_lshl_b32 s63, s53, 6
    s_add_u32 s55, s55, s63
    v_lshlrev_b32 v13, 3, v12
    v_add_u32 v13, s55, v13
    v_add_u32 v11, v11, v13
    s_waitcnt vmcnt(40)
    ds_read_b64_tr_b16 v[192:193], v8 offset:0
    ds_read_b64_tr_b16 v[194:195], v8 offset:1024
    ds_read_b64_tr_b16 v[196:197], v9 offset:0
    ds_read_b64_tr_b16 v[198:199], v9 offset:1024
    ds_read_b64_tr_b16 v[200:201], v8 offset:2048
    ds_read_b64_tr_b16 v[202:203], v8 offset:3072
    ds_read_b64_tr_b16 v[204:205], v9 offset:2048
    ds_read_b64_tr_b16 v[206:207], v9 offset:3072
    s_mov_b32 s63, 0x358637bd
    s_waitcnt vmcnt(32)
    s_waitcnt lgkmcnt(0)
    ds_read_b64_tr_b16 v[208:209], v8 offset:4096
    ds_read_b64_tr_b16 v[210:211], v8 offset:5120
    ds_read_b64_tr_b16 v[212:213], v9 offset:4096
    ds_read_b64_tr_b16 v[214:215], v9 offset:5120
    ds_read_b64_tr_b16 v[216:217], v8 offset:6144
    ds_read_b64_tr_b16 v[218:219], v8 offset:7168
    ds_read_b64_tr_b16 v[220:221], v9 offset:6144
    ds_read_b64_tr_b16 v[222:223], v9 offset:7168
    v_mfma_f32_32x32x16_bf16 a[128:143], v[192:195], a[0:3], 0
    buffer_load_dwordx4 a[96:99], v3, s[16:19], s56 offen offset:0
    v_mfma_f32_32x32x16_bf16 a[144:159], v[192:195], a[8:11], 0
    buffer_load_dwordx4 a[100:103], v3, s[16:19], s56 offen offset:1024
    v_mfma_f32_32x32x16_bf16 a[160:175], v[196:199], a[0:3], 0
    buffer_load_dwordx4 a[104:107], v4, s[16:19], s56 offen offset:0
    v_mfma_f32_32x32x16_bf16 a[176:191], v[196:199], a[8:11], 0
    buffer_load_dwordx4 a[108:111], v4, s[16:19], s56 offen offset:1024
    s_add_u32 s56, s56, 2048
    v_mfma_f32_32x32x16_bf16 a[128:143], v[200:203], a[4:7], a[128:143]
    s_add_u32 m0, s61, 24576
    s_nop 0
    buffer_load_dwordx4 v7, s[4:7], s58 offen lds
    s_add_u32 s58, s58, 8192
    v_mfma_f32_32x32x16_bf16 a[144:159], v[200:203], a[12:15], a[144:159]
    s_add_u32 m0, s61, 25600
    s_nop 0
    buffer_load_dwordx4 v7, s[4:7], s58 offen lds
    s_add_u32 s58, s58, 8192
    v_mfma_f32_32x32x16_bf16 a[160:175], v[204:207], a[4:7], a[160:175]
    s_add_u32 m0, s61, 26624
    s_nop 0
    buffer_load_dwordx4 v7, s[4:7], s58 offen lds
    s_add_u32 s58, s58, 8192
    v_mfma_f32_32x32x16_bf16 a[176:191], v[204:207], a[12:15], a[176:191]
    s_add_u32 m0, s61, 27648
    s_nop 0
    buffer_load_dwordx4 v7, s[4:7], s58 offen lds
    s_add_u32 s58, s58, 8192
    s_waitcnt vmcnt(32)
    s_waitcnt lgkmcnt(0)
    ds_read_b64_tr_b16 v[192:193], v8 offset:8192
    ds_read_b64_tr_b16 v[194:195], v8 offset:9216
    ds_read_b64_tr_b16 v[196:197], v9 offset:8192
    ds_read_b64_tr_b16 v[198:199], v9 offset:9216
    ds_read_b64_tr_b16 v[200:201], v8 offset:10240
    ds_read_b64_tr_b16 v[202:203], v8 offset:11264
    ds_read_b64_tr_b16 v[204:205], v9 offset:10240
    ds_read_b64_tr_b16 v[206:207], v9 offset:11264
    v_mfma_f32_32x32x16_bf16 a[128:143], v[208:211], a[16:19], a[128:143]
    buffer_load_dwordx4 a[0:3], v3, s[16:19], s56 offen offset:0
    v_mfma_f32_32x32x16_bf16 a[144:159], v[208:211], a[24:27], a[144:159]
    buffer_load_dwordx4 a[4:7], v3, s[16:19], s56 offen offset:1024
    v_mfma_f32_32x32x16_bf16 a[160:175], v[212:215], a[16:19], a[160:175]
    buffer_load_dwordx4 a[8:11], v4, s[16:19], s56 offen offset:0
    v_mfma_f32_32x32x16_bf16 a[176:191], v[212:215], a[24:27], a[176:191]
    buffer_load_dwordx4 a[12:15], v4, s[16:19], s56 offen offset:1024
    s_add_u32 s56, s56, 2048
    v_mfma_f32_32x32x16_bf16 a[128:143], v[216:219], a[20:23], a[128:143]
    s_add_u32 m0, s61, 0
    s_nop 0
    buffer_load_dwordx4 v7, s[4:7], s58 offen lds
    s_add_u32 s58, s58, 8192
    v_mfma_f32_32x32x16_bf16 a[144:159], v[216:219], a[28:31], a[144:159]
    s_add_u32 m0, s61, 1024
    s_nop 0
    buffer_load_dwordx4 v7, s[4:7], s58 offen lds
    s_add_u32 s58, s58, 8192
    v_mfma_f32_32x32x16_bf16 a[160:175], v[220:223], a[20:23], a[160:175]
    s_add_u32 m0, s61, 2048
    s_nop 0
    buffer_load_dwordx4 v7, s[4:7], s58 offen lds
    s_add_u32 s58, s58, 8192
    v_mfma_f32_32x32x16_bf16 a[176:191], v[220:223], a[28:31], a[176:191]
    s_add_u32 m0, s61, 3072
    s_nop 0
    buffer_load_dwordx4 v7, s[4:7], s58 offen lds
    s_add_u32 s58, s58, 8192
    s_waitcnt vmcnt(32)
    s_waitcnt lgkmcnt(0)
    ds_read_b64_tr_b16 v[208:209], v8 offset:12288
    ds_read_b64_tr_b16 v[210:211], v8 offset:13312
    ds_read_b64_tr_b16 v[212:213], v9 offset:12288
    ds_read_b64_tr_b16 v[214:215], v9 offset:13312
    ds_read_b64_tr_b16 v[216:217], v8 offset:14336
    ds_read_b64_tr_b16 v[218:219], v8 offset:15360
    ds_read_b64_tr_b16 v[220:221], v9 offset:14336
    ds_read_b64_tr_b16 v[222:223], v9 offset:15360
    v_mfma_f32_32x32x16_bf16 a[128:143], v[192:195], a[32:35], a[128:143]
    buffer_load_dwordx4 a[16:19], v3, s[16:19], s56 offen offset:0
    v_mfma_f32_32x32x16_bf16 a[144:159], v[192:195], a[40:43], a[144:159]
    buffer_load_dwordx4 a[20:23], v3, s[16:19], s56 offen offset:1024
    v_mfma_f32_32x32x16_bf16 a[160:175], v[196:199], a[32:35], a[160:175]
    buffer_load_dwordx4 a[24:27], v4, s[16:19], s56 offen offset:0
    v_mfma_f32_32x32x16_bf16 a[176:191], v[196:199], a[40:43], a[176:191]
    buffer_load_dwordx4 a[28:31], v4, s[16:19], s56 offen offset:1024
    s_add_u32 s56, s56, 2048
    v_mfma_f32_32x32x16_bf16 a[128:143], v[200:203], a[36:39], a[128:143]
    s_add_u32 m0, s61, 4096
    s_nop 0
    buffer_load_dwordx4 v7, s[4:7], s58 offen lds
    s_add_u32 s58, s58, 8192
    v_mfma_f32_32x32x16_bf16 a[144:159], v[200:203], a[44:47], a[144:159]
    s_add_u32 m0, s61, 5120
    s_nop 0
    buffer_load_dwordx4 v7, s[4:7], s58 offen lds
    s_add_u32 s58, s58, 8192
    v_mfma_f32_32x32x16_bf16 a[160:175], v[204:207], a[36:39], a[160:175]
    s_add_u32 m0, s61, 6144
    s_nop 0
    buffer_load_dwordx4 v7, s[4:7], s58 offen lds
    s_add_u32 s58, s58, 8192
    v_mfma_f32_32x32x16_bf16 a[176:191], v[204:207], a[44:47], a[176:191]
    s_add_u32 m0, s61, 7168
    s_nop 0
    buffer_load_dwordx4 v7, s[4:7], s58 offen lds
    s_add_u32 s58, s58, 8192
    s_waitcnt vmcnt(32)
    s_waitcnt lgkmcnt(0)
    ds_read_b64_tr_b16 v[192:193], v8 offset:16384
    ds_read_b64_tr_b16 v[194:195], v8 offset:17408
    ds_read_b64_tr_b16 v[196:197], v9 offset:16384
    ds_read_b64_tr_b16 v[198:199], v9 offset:17408
    ds_read_b64_tr_b16 v[200:201], v8 offset:18432
    ds_read_b64_tr_b16 v[202:203], v8 offset:19456
    ds_read_b64_tr_b16 v[204:205], v9 offset:18432
    ds_read_b64_tr_b16 v[206:207], v9 offset:19456
    v_mfma_f32_32x32x16_bf16 a[128:143], v[208:211], a[48:51], a[128:143]
    buffer_load_dwordx4 a[32:35], v3, s[16:19], s56 offen offset:0
    v_mfma_f32_32x32x16_bf16 a[144:159], v[208:211], a[56:59], a[144:159]
    buffer_load_dwordx4 a[36:39], v3, s[16:19], s56 offen offset:1024
    v_mfma_f32_32x32x16_bf16 a[160:175], v[212:215], a[48:51], a[160:175]
    buffer_load_dwordx4 a[40:43], v4, s[16:19], s56 offen offset:0
    v_mfma_f32_32x32x16_bf16 a[176:191], v[212:215], a[56:59], a[176:191]
    buffer_load_dwordx4 a[44:47], v4, s[16:19], s56 offen offset:1024
    s_add_u32 s56, s56, 2048
    v_mfma_f32_32x32x16_bf16 a[128:143], v[216:219], a[52:55], a[128:143]
    s_add_u32 m0, s61, 8192
    s_nop 0
    buffer_load_dwordx4 v7, s[4:7], s58 offen lds
    s_add_u32 s58, s58, 8192
    v_mfma_f32_32x32x16_bf16 a[144:159], v[216:219], a[60:63], a[144:159]
    s_add_u32 m0, s61, 9216
    s_nop 0
    buffer_load_dwordx4 v7, s[4:7], s58 offen lds
    s_add_u32 s58, s58, 8192
    v_mfma_f32_32x32x16_bf16 a[160:175], v[220:223], a[52:55], a[160:175]
    s_add_u32 m0, s61, 10240
    s_nop 0
    buffer_load_dwordx4 v7, s[4:7], s58 offen lds
    s_add_u32 s58, s58, 8192
    v_mfma_f32_32x32x16_bf16 a[176:191], v[220:223], a[60:63], a[176:191]
    s_add_u32 m0, s61, 11264
    s_nop 0
    buffer_load_dwordx4 v7, s[4:7], s58 offen lds
    s_add_u32 s58, s58, 8192
    s_waitcnt vmcnt(32)
    s_waitcnt lgkmcnt(0)
    ds_read_b64_tr_b16 v[208:209], v8 offset:20480
    ds_read_b64_tr_b16 v[210:211], v8 offset:21504
    ds_read_b64_tr_b16 v[212:213], v9 offset:20480
    ds_read_b64_tr_b16 v[214:215], v9 offset:21504
    ds_read_b64_tr_b16 v[216:217], v8 offset:22528
    ds_read_b64_tr_b16 v[218:219], v8 offset:23552
    ds_read_b64_tr_b16 v[220:221], v9 offset:22528
    ds_read_b64_tr_b16 v[222:223], v9 offset:23552
    v_mfma_f32_32x32x16_bf16 a[128:143], v[192:195], a[64:67], a[128:143]
    s_cmp_eq_u32 s50, 3
    s_cselect_b32 s55, 2048, 0
    s_sub_u32 s56, s56, s55
    s_lshl_b32 s55, s55, 4
    s_sub_u32 s58, s58, s55
    buffer_load_dwordx4 a[48:51], v3, s[16:19], s56 offen offset:0
    v_mfma_f32_32x32x16_bf16 a[144:159], v[192:195], a[72:75], a[144:159]
    buffer_load_dwordx4 a[52:55], v3, s[16:19], s56 offen offset:1024
    v_mfma_f32_32x32x16_bf16 a[160:175], v[196:199], a[64:67], a[160:175]
    buffer_load_dwordx4 a[56:59], v4, s[16:19], s56 offen offset:0
    v_mfma_f32_32x32x16_bf16 a[176:191], v[196:199], a[72:75], a[176:191]
    buffer_load_dwordx4 a[60:63], v4, s[16:19], s56 offen offset:1024
    s_add_u32 s56, s56, 2048
    v_mfma_f32_32x32x16_bf16 a[128:143], v[200:203], a[68:71], a[128:143]
    s_add_u32 m0, s61, 12288
    s_nop 0
    buffer_load_dwordx4 v7, s[4:7], s58 offen lds
    s_add_u32 s58, s58, 8192
    v_mfma_f32_32x32x16_bf16 a[144:159], v[200:203], a[76:79], a[144:159]
    s_add_u32 m0, s61, 13312
    s_nop 0
    buffer_load_dwordx4 v7, s[4:7], s58 offen lds
    s_add_u32 s58, s58, 8192
    v_mfma_f32_32x32x16_bf16 a[160:175], v[204:207], a[68:71], a[160:175]
    s_add_u32 m0, s61, 14336
    s_nop 0
    buffer_load_dwordx4 v7, s[4:7], s58 offen lds
    s_add_u32 s58, s58, 8192
    v_mfma_f32_32x32x16_bf16 a[176:191], v[204:207], a[76:79], a[176:191]
    s_add_u32 m0, s61, 15360
    s_nop 0
    buffer_load_dwordx4 v7, s[4:7], s58 offen lds
    s_add_u32 s58, s58, 8192
    s_waitcnt vmcnt(32)
    s_waitcnt lgkmcnt(0)
    ds_read_b64_tr_b16 v[192:193], v8 offset:24576
    ds_read_b64_tr_b16 v[194:195], v8 offset:25600
    ds_read_b64_tr_b16 v[196:197], v9 offset:24576
    ds_read_b64_tr_b16 v[198:199], v9 offset:25600
    ds_read_b64_tr_b16 v[200:201], v8 offset:26624
    ds_read_b64_tr_b16 v[202:203], v8 offset:27648
    ds_read_b64_tr_b16 v[204:205], v9 offset:26624
    ds_read_b64_tr_b16 v[206:207], v9 offset:27648
    v_mfma_f32_32x32x16_bf16 a[128:143], v[208:211], a[80:83], a[128:143]
    buffer_load_dwordx4 a[64:67], v5, s[12:15], s57 offen offset:0
    v_mfma_f32_32x32x16_bf16 a[144:159], v[208:211], a[88:91], a[144:159]
    buffer_load_dwordx4 a[68:71], v5, s[12:15], s57 offen offset:1024
    v_mfma_f32_32x32x16_bf16 a[160:175], v[212:215], a[80:83], a[160:175]
    buffer_load_dwordx4 a[72:75], v6, s[12:15], s57 offen offset:0
    v_mfma_f32_32x32x16_bf16 a[176:191], v[212:215], a[88:91], a[176:191]
    buffer_load_dwordx4 a[76:79], v6, s[12:15], s57 offen offset:1024
    s_add_u32 s57, s57, 2048
    v_mfma_f32_32x32x16_bf16 a[128:143], v[216:219], a[84:87], a[128:143]
    s_add_u32 m0, s61, 16384
    s_nop 0
    buffer_load_dwordx4 v7, s[8:11], s59 offen lds
    s_add_u32 s59, s59, 8192
    v_mfma_f32_32x32x16_bf16 a[144:159], v[216:219], a[92:95], a[144:159]
    s_add_u32 m0, s61, 17408
    s_nop 0
    buffer_load_dwordx4 v7, s[8:11], s59 offen lds
    s_add_u32 s59, s59, 8192
    v_mfma_f32_32x32x16_bf16 a[160:175], v[220:223], a[84:87], a[160:175]
    v_mfma_f32_32x32x16_bf16 a[176:191], v[220:223], a[92:95], a[176:191]
    s_lshl_b32 s3, s50, 14
    s_add_u32 s3, s3, 12582912
    v_mov_b32 v22, v2
    v_add_u32 v23, 4096, v2
    v_add_u32 v24, 8192, v2
    v_add_u32 v25, 12288, v2
    s_waitcnt vmcnt(30)
    s_waitcnt lgkmcnt(0)
    ds_read_b64_tr_b16 v[208:209], v8 offset:0
    ds_read_b64_tr_b16 v[210:211], v8 offset:1024
    ds_read_b64_tr_b16 v[212:213], v9 offset:0
    ds_read_b64_tr_b16 v[214:215], v9 offset:1024
    ds_read_b64_tr_b16 v[216:217], v8 offset:2048
    ds_read_b64_tr_b16 v[218:219], v8 offset:3072
    ds_read_b64_tr_b16 v[220:221], v9 offset:2048
    ds_read_b64_tr_b16 v[222:223], v9 offset:3072
    v_mfma_f32_32x32x16_bf16 a[128:143], v[192:195], a[96:99], a[128:143]
    buffer_load_dwordx4 a[80:83], v5, s[12:15], s57 offen offset:0
    buffer_load_dwordx4 a[84:87], v5, s[12:15], s57 offen offset:1024
    buffer_load_dwordx4 a[88:91], v6, s[12:15], s57 offen offset:0
    v_mfma_f32_32x32x16_bf16 a[144:159], v[192:195], a[104:107], a[144:159]
    buffer_load_dwordx4 a[92:95], v6, s[12:15], s57 offen offset:1024
    s_add_u32 s57, s57, 2048
    s_add_u32 m0, s61, 20480
    s_nop 0
    buffer_load_dwordx4 v7, s[8:11], s59 offen lds
    s_add_u32 s59, s59, 8192
    s_add_u32 m0, s61, 21504
    s_nop 0
    buffer_load_dwordx4 v7, s[8:11], s59 offen lds
    s_add_u32 s59, s59, 8192
    v_mfma_f32_32x32x16_bf16 a[160:175], v[196:199], a[96:99], a[160:175]
    buffer_load_dwordx4 v[64:67], v22, s[12:15], s3 offen offset:0
    buffer_load_dwordx4 v[68:71], v22, s[12:15], s3 offen offset:1024
    buffer_load_dwordx4 v[72:75], v22, s[12:15], s3 offen offset:2048
    v_mfma_f32_32x32x16_bf16 a[176:191], v[196:199], a[104:107], a[176:191]
    buffer_load_dwordx4 v[76:79], v22, s[12:15], s3 offen offset:3072
    buffer_load_dwordx4 v[80:83], v23, s[12:15], s3 offen offset:0
    buffer_load_dwordx4 v[84:87], v23, s[12:15], s3 offen offset:1024
    v_mfma_f32_32x32x16_bf16 a[128:143], v[200:203], a[100:103], a[128:143]
    buffer_load_dwordx4 v[88:91], v23, s[12:15], s3 offen offset:2048
    buffer_load_dwordx4 v[92:95], v23, s[12:15], s3 offen offset:3072
    buffer_load_dwordx4 v[96:99], v24, s[12:15], s3 offen offset:0
    v_mfma_f32_32x32x16_bf16 a[144:159], v[200:203], a[108:111], a[144:159]
    buffer_load_dwordx4 v[100:103], v24, s[12:15], s3 offen offset:1024
    buffer_load_dwordx4 v[104:107], v24, s[12:15], s3 offen offset:2048
    buffer_load_dwordx4 v[108:111], v24, s[12:15], s3 offen offset:3072
    v_mfma_f32_32x32x16_bf16 a[160:175], v[204:207], a[100:103], a[160:175]
    buffer_load_dwordx4 v[112:115], v25, s[12:15], s3 offen offset:0
    buffer_load_dwordx4 v[116:119], v25, s[12:15], s3 offen offset:1024
    buffer_load_dwordx4 v[120:123], v25, s[12:15], s3 offen offset:2048
    v_mfma_f32_32x32x16_bf16 a[176:191], v[204:207], a[108:111], a[176:191]
    buffer_load_dwordx4 v[124:127], v25, s[12:15], s3 offen offset:3072
    s_waitcnt vmcnt(44)
    s_waitcnt lgkmcnt(0)
    ds_read_b64_tr_b16 v[192:193], v8 offset:4096
    ds_read_b64_tr_b16 v[194:195], v8 offset:5120
    ds_read_b64_tr_b16 v[196:197], v9 offset:4096
    ds_read_b64_tr_b16 v[198:199], v9 offset:5120
    ds_read_b64_tr_b16 v[200:201], v8 offset:6144
    ds_read_b64_tr_b16 v[202:203], v8 offset:7168
    ds_read_b64_tr_b16 v[204:205], v9 offset:6144
    ds_read_b64_tr_b16 v[206:207], v9 offset:7168
    v_mfma_f32_32x32x16_bf16 a[128:143], v[208:211], a[0:3], a[128:143]
    buffer_load_dwordx4 a[96:99], v5, s[12:15], s57 offen offset:0
    v_mfma_f32_32x32x16_bf16 a[144:159], v[208:211], a[8:11], a[144:159]
    buffer_load_dwordx4 a[100:103], v5, s[12:15], s57 offen offset:1024
    v_mfma_f32_32x32x16_bf16 a[160:175], v[212:215], a[0:3], a[160:175]
    buffer_load_dwordx4 a[104:107], v6, s[12:15], s57 offen offset:0
    v_mfma_f32_32x32x16_bf16 a[176:191], v[212:215], a[8:11], a[176:191]
    buffer_load_dwordx4 a[108:111], v6, s[12:15], s57 offen offset:1024
    s_add_u32 s57, s57, 2048
    v_mfma_f32_32x32x16_bf16 a[128:143], v[216:219], a[4:7], a[128:143]
    s_add_u32 m0, s61, 24576
    s_nop 0
    buffer_load_dwordx4 v7, s[8:11], s59 offen lds
    s_add_u32 s59, s59, 8192
    v_mfma_f32_32x32x16_bf16 a[144:159], v[216:219], a[12:15], a[144:159]
    s_add_u32 m0, s61, 25600
    s_nop 0
    buffer_load_dwordx4 v7, s[8:11], s59 offen lds
    s_add_u32 s59, s59, 8192
    v_mfma_f32_32x32x16_bf16 a[160:175], v[220:223], a[4:7], a[160:175]
    v_mfma_f32_32x32x16_bf16 a[176:191], v[220:223], a[12:15], a[176:191]
    s_waitcnt vmcnt(42)
    s_waitcnt lgkmcnt(0)
    ds_read_b64_tr_b16 v[208:209], v8 offset:8192
    ds_read_b64_tr_b16 v[210:211], v8 offset:9216
    ds_read_b64_tr_b16 v[212:213], v9 offset:8192
    ds_read_b64_tr_b16 v[214:215], v9 offset:9216
    ds_read_b64_tr_b16 v[216:217], v8 offset:10240
    ds_read_b64_tr_b16 v[218:219], v8 offset:11264
    ds_read_b64_tr_b16 v[220:221], v9 offset:10240
    ds_read_b64_tr_b16 v[222:223], v9 offset:11264
    v_mfma_f32_32x32x16_bf16 a[128:143], v[192:195], a[16:19], a[128:143]
    buffer_load_dwordx4 a[0:3], v5, s[12:15], s57 offen offset:0
    v_mfma_f32_32x32x16_bf16 a[144:159], v[192:195], a[24:27], a[144:159]
    buffer_load_dwordx4 a[4:7], v5, s[12:15], s57 offen offset:1024
    v_mfma_f32_32x32x16_bf16 a[160:175], v[196:199], a[16:19], a[160:175]
    buffer_load_dwordx4 a[8:11], v6, s[12:15], s57 offen offset:0
    v_mfma_f32_32x32x16_bf16 a[176:191], v[196:199], a[24:27], a[176:191]
    buffer_load_dwordx4 a[12:15], v6, s[12:15], s57 offen offset:1024
    s_add_u32 s57, s57, 2048
    v_mfma_f32_32x32x16_bf16 a[128:143], v[200:203], a[20:23], a[128:143]
    s_add_u32 m0, s61, 0
    s_nop 0
    buffer_load_dwordx4 v7, s[8:11], s59 offen lds
    s_add_u32 s59, s59, 8192
    v_mfma_f32_32x32x16_bf16 a[144:159], v[200:203], a[28:31], a[144:159]
    s_add_u32 m0, s61, 1024
    s_nop 0
    buffer_load_dwordx4 v7, s[8:11], s59 offen lds
    s_add_u32 s59, s59, 8192
    v_mfma_f32_32x32x16_bf16 a[160:175], v[204:207], a[20:23], a[160:175]
    v_mfma_f32_32x32x16_bf16 a[176:191], v[204:207], a[28:31], a[176:191]
    s_waitcnt vmcnt(40)
    s_waitcnt lgkmcnt(0)
    ds_read_b64_tr_b16 v[192:193], v8 offset:12288
    ds_read_b64_tr_b16 v[194:195], v8 offset:13312
    ds_read_b64_tr_b16 v[196:197], v9 offset:12288
    ds_read_b64_tr_b16 v[198:199], v9 offset:13312
    ds_read_b64_tr_b16 v[200:201], v8 offset:14336
    ds_read_b64_tr_b16 v[202:203], v8 offset:15360
    ds_read_b64_tr_b16 v[204:205], v9 offset:14336
    ds_read_b64_tr_b16 v[206:207], v9 offset:15360
    v_mfma_f32_32x32x16_bf16 a[128:143], v[208:211], a[32:35], a[128:143]
    buffer_load_dwordx4 a[16:19], v5, s[12:15], s57 offen offset:0
    v_mfma_f32_32x32x16_bf16 a[144:159], v[208:211], a[40:43], a[144:159]
    buffer_load_dwordx4 a[20:23], v5, s[12:15], s57 offen offset:1024
    v_mfma_f32_32x32x16_bf16 a[160:175], v[212:215], a[32:35], a[160:175]
    buffer_load_dwordx4 a[24:27], v6, s[12:15], s57 offen offset:0
    v_mfma_f32_32x32x16_bf16 a[176:191], v[212:215], a[40:43], a[176:191]
    buffer_load_dwordx4 a[28:31], v6, s[12:15], s57 offen offset:1024
    s_add_u32 s57, s57, 2048
    v_mfma_f32_32x32x16_bf16 a[128:143], v[216:219], a[36:39], a[128:143]
    s_add_u32 m0, s61, 4096
    s_nop 0
    buffer_load_dwordx4 v7, s[8:11], s59 offen lds
    s_add_u32 s59, s59, 8192
    v_mfma_f32_32x32x16_bf16 a[144:159], v[216:219], a[44:47], a[144:159]
    s_add_u32 m0, s61, 5120
    s_nop 0
    buffer_load_dwordx4 v7, s[8:11], s59 offen lds
    s_add_u32 s59, s59, 8192
    v_mfma_f32_32x32x16_bf16 a[160:175], v[220:223], a[36:39], a[160:175]
    v_mfma_f32_32x32x16_bf16 a[176:191], v[220:223], a[44:47], a[176:191]
    s_waitcnt vmcnt(40)
    s_waitcnt vmcnt(18)
    s_mov_b32 s55, 0
K2_CHK:
    v_max3_u32 v14, v64, v65, v66
    v_max3_u32 v15, v67, v68, v69
    v_max3_u32 v14, v14, v70, v71
    v_max3_u32 v15, v15, v72, v73
    v_max3_u32 v14, v14, v74, v75
    v_max3_u32 v15, v15, v76, v77
    v_max3_u32 v14, v14, v78, v79
    v_max3_u32 v15, v15, v80, v81
    v_max3_u32 v14, v14, v82, v83
    v_max3_u32 v15, v15, v84, v85
    v_max3_u32 v14, v14, v86, v87
    v_max3_u32 v15, v15, v88, v89
    v_max3_u32 v14, v14, v90, v91
    v_max3_u32 v15, v15, v92, v93
    v_max3_u32 v14, v14, v94, v95
    v_max3_u32 v15, v15, v96, v97
    v_max3_u32 v14, v14, v98, v99
    v_max3_u32 v15, v15, v100, v101
    v_max3_u32 v14, v14, v102, v103
    v_max3_u32 v15, v15, v104, v105
    v_max3_u32 v14, v14, v106, v107
    v_max3_u32 v15, v15, v108, v109
    v_max3_u32 v14, v14, v110, v111
    v_max3_u32 v15, v15, v112, v113
    v_max3_u32 v14, v14, v114, v115
    v_max3_u32 v15, v15, v116, v117
    v_max3_u32 v14, v14, v118, v119
    v_max3_u32 v15, v15, v120, v121
    v_max3_u32 v14, v14, v122, v123
    v_max3_u32 v15, v15, v124, v125
    v_max3_u32 v14, v14, v126, v127
    v_max_u32 v14, v14, v15
    v_cmp_eq_u32 vcc, -1, v14
    s_cbranch_vccz K2_GO
    s_add_u32 s55, s55, 1
    s_cmp_gt_u32 s55, 0x10000
    s_cbranch_scc1 K2_GO
    s_sleep 8
    buffer_load_dwordx4 v[64:67], v22, s[12:15], s3 offen offset:0 sc1
    buffer_load_dwordx4 v[68:71], v22, s[12:15], s3 offen offset:1024 sc1
    buffer_load_dwordx4 v[72:75], v22, s[12:15], s3 offen offset:2048 sc1
    buffer_load_dwordx4 v[76:79], v22, s[12:15], s3 offen offset:3072 sc1
    buffer_load_dwordx4 v[80:83], v23, s[12:15], s3 offen offset:0 sc1
    buffer_load_dwordx4 v[84:87], v23, s[12:15], s3 offen offset:1024 sc1
    buffer_load_dwordx4 v[88:91], v23, s[12:15], s3 offen offset:2048 sc1
    buffer_load_dwordx4 v[92:95], v23, s[12:15], s3 offen offset:3072 sc1
    buffer_load_dwordx4 v[96:99], v24, s[12:15], s3 offen offset:0 sc1
    buffer_load_dwordx4 v[100:103], v24, s[12:15], s3 offen offset:1024 sc1
    buffer_load_dwordx4 v[104:107], v24, s[12:15], s3 offen offset:2048 sc1
    buffer_load_dwordx4 v[108:111], v24, s[12:15], s3 offen offset:3072 sc1
    buffer_load_dwordx4 v[112:115], v25, s[12:15], s3 offen offset:0 sc1
    buffer_load_dwordx4 v[116:119], v25, s[12:15], s3 offen offset:1024 sc1
    buffer_load_dwordx4 v[120:123], v25, s[12:15], s3 offen offset:2048 sc1
    buffer_load_dwordx4 v[124:127], v25, s[12:15], s3 offen offset:3072 sc1
    s_waitcnt vmcnt(0)
    s_branch K2_CHK
K2_GO:
    s_waitcnt lgkmcnt(0)
    ds_read_b64_tr_b16 v[208:209], v8 offset:16384
    ds_read_b64_tr_b16 v[210:211], v8 offset:17408
    ds_read_b64_tr_b16 v[212:213], v9 offset:16384
    ds_read_b64_tr_b16 v[214:215], v9 offset:17408
    s_cmp_lg_u32 s50, 3
    s_cbranch_scc1 K2_NZ
    v_mov_b32 v192, 0
    v_mov_b32 v193, 0
    v_mov_b32 v194, 0
    v_mov_b32 v195, 0
    v_mov_b32 v196, 0
    v_mov_b32 v197, 0
    v_mov_b32 v198, 0
    v_mov_b32 v199, 0
    v_mov_b32 v200, 0
    v_mov_b32 v201, 0
    v_mov_b32 v202, 0
    v_mov_b32 v203, 0
    v_mov_b32 v204, 0
    v_mov_b32 v205, 0
    v_mov_b32 v206, 0
    v_mov_b32 v207, 0
K2_NZ:
    v_mfma_f32_32x32x16_bf16 a[128:143], v[192:195], a[48:51], a[128:143]
    buffer_load_dwordx4 a[32:35], v5, s[12:15], s57 offen offset:0
    v_mfma_f32_32x32x16_bf16 a[144:159], v[192:195], a[56:59], a[144:159]
    buffer_load_dwordx4 a[36:39], v5, s[12:15], s57 offen offset:1024
    v_mfma_f32_32x32x16_bf16 a[160:175], v[196:199], a[48:51], a[160:175]
    buffer_load_dwordx4 a[40:43], v6, s[12:15], s57 offen offset:0
    v_mfma_f32_32x32x16_bf16 a[176:191], v[196:199], a[56:59], a[176:191]
    buffer_load_dwordx4 a[44:47], v6, s[12:15], s57 offen offset:1024
    s_add_u32 s57, s57, 2048
    v_mfma_f32_32x32x16_bf16 a[128:143], v[200:203], a[52:55], a[128:143]
    s_add_u32 m0, s61, 8192
    s_nop 0
    buffer_load_dwordx4 v7, s[8:11], s59 offen lds
    s_add_u32 s59, s59, 8192
    v_mfma_f32_32x32x16_bf16 a[144:159], v[200:203], a[60:63], a[144:159]
    s_add_u32 m0, s61, 9216
    s_nop 0
    buffer_load_dwordx4 v7, s[8:11], s59 offen lds
    s_add_u32 s59, s59, 8192
    v_mfma_f32_32x32x16_bf16 a[160:175], v[204:207], a[52:55], a[160:175]
    v_mfma_f32_32x32x16_bf16 a[176:191], v[204:207], a[60:63], a[176:191]
    v_mfma_f32_32x32x16_bf16 v[160:175], v[64:67], a[64:67], 0
    v_mfma_f32_32x32x16_bf16 v[176:191], v[64:67], a[72:75], 0
    v_mfma_f32_32x32x16_bf16 v[160:175], v[68:71], a[68:71], v[160:175]
    v_mfma_f32_32x32x16_bf16 v[176:191], v[68:71], a[76:79], v[176:191]
    s_waitcnt lgkmcnt(0)
    ds_read_b64_tr_b16 v[192:193], v8 offset:20480
    ds_read_b64_tr_b16 v[194:195], v8 offset:21504
    ds_read_b64_tr_b16 v[196:197], v9 offset:20480
    ds_read_b64_tr_b16 v[198:199], v9 offset:21504
    v_mfma_f32_32x32x16_bf16 v[128:143], v[72:75], a[80:83], 0
    s_nop 4
    v_add_f32 v14, s63, v168
    v_add_f32 v15, s63, v184
    v_rcp_f32 v14, v14
    v_rcp_f32 v15, v15
    v_mul_f32 v160, v160, v14
    v_mul_f32 v161, v161, v14
    v_mul_f32 v162, v162, v14
    buffer_load_dwordx4 a[48:51], v5, s[12:15], s57 offen offset:0
    v_mfma_f32_32x32x16_bf16 v[144:159], v[72:75], a[88:91], 0
    v_mul_f32 v163, v163, v14
    v_mul_f32 v164, v164, v14
    v_mul_f32 v165, v165, v14
    v_mul_f32 v166, v166, v14
    v_mul_f32 v167, v167, v14
    v_cvt_pk_bf16_f32 v224, v160, v161
    v_cvt_pk_bf16_f32 v225, v162, v163
    buffer_load_dwordx4 a[52:55], v5, s[12:15], s57 offen offset:1024
    v_mfma_f32_32x32x16_bf16 v[128:143], v[76:79], a[84:87], v[128:143]
    v_cvt_pk_bf16_f32 v226, v164, v165
    v_cvt_pk_bf16_f32 v227, v166, v167
    v_mul_f32 v176, v176, v15
    v_mul_f32 v177, v177, v15
    v_mul_f32 v178, v178, v15
    v_mul_f32 v179, v179, v15
    v_mul_f32 v180, v180, v15
    buffer_load_dwordx4 a[56:59], v6, s[12:15], s57 offen offset:0
    v_mfma_f32_32x32x16_bf16 v[144:159], v[76:79], a[92:95], v[144:159]
    v_mul_f32 v181, v181, v15
    v_mul_f32 v182, v182, v15
    v_mul_f32 v183, v183, v15
    v_cvt_pk_bf16_f32 v228, v176, v177
    v_cvt_pk_bf16_f32 v229, v178, v179
    v_cvt_pk_bf16_f32 v230, v180, v181
    v_cvt_pk_bf16_f32 v231, v182, v183
    buffer_load_dwordx4 a[60:63], v6, s[12:15], s57 offen offset:1024
    s_add_u32 s57, s57, 2048
    v_mfma_f32_32x32x16_bf16 a[128:143], v[208:211], v[224:227], a[128:143]
    s_add_u32 m0, s61, 12288
    s_nop 0
    buffer_load_dwordx4 v7, s[8:11], s59 offen lds
    s_add_u32 s59, s59, 8192
    v_mfma_f32_32x32x16_bf16 a[160:175], v[212:215], v[224:227], a[160:175]
    s_add_u32 m0, s61, 13312
    s_nop 0
    buffer_load_dwordx4 v7, s[8:11], s59 offen lds
    s_add_u32 s59, s59, 8192
    v_mfma_f32_32x32x16_bf16 a[144:159], v[208:211], v[228:231], a[144:159]
    v_mfma_f32_32x32x16_bf16 a[176:191], v[212:215], v[228:231], a[176:191]
    s_waitcnt vmcnt(24)
    s_waitcnt lgkmcnt(0)
    ds_read_b64_tr_b16 v[208:209], v8 offset:24576
    ds_read_b64_tr_b16 v[210:211], v8 offset:25600
    ds_read_b64_tr_b16 v[212:213], v9 offset:24576
    ds_read_b64_tr_b16 v[214:215], v9 offset:25600
    v_mfma_f32_32x32x16_bf16 v[160:175], v[80:83], a[96:99], 0
    v_add_f32 v14, s63, v128
    v_add_f32 v15, s63, v144
    v_rcp_f32 v14, v14
    v_rcp_f32 v15, v15
    v_mul_f32 v136, v136, v14
    v_mul_f32 v137, v137, v14
    v_mul_f32 v138, v138, v14
    buffer_load_dwordx4 a[64:67], v5, s[12:15], s57 offen offset:0
    buffer_load_dwordx4 a[68:71], v5, s[12:15], s57 offen offset:1024
    v_mfma_f32_32x32x16_bf16 v[176:191], v[80:83], a[104:107], 0
    v_mul_f32 v139, v139, v14
    v_mul_f32 v140, v140, v14
    v_mul_f32 v141, v141, v14
    v_mul_f32 v142, v142, v14
    v_mul_f32 v143, v143, v14
    v_cvt_pk_bf16_f32 v224, v136, v137
    v_cvt_pk_bf16_f32 v225, v138, v139
    buffer_load_dwordx4 a[72:75], v6, s[12:15], s57 offen offset:0
    buffer_load_dwordx4 a[76:79], v6, s[12:15], s57 offen offset:1024
    s_add_u32 s57, s57, 2048
    v_mfma_f32_32x32x16_bf16 v[160:175], v[84:87], a[100:103], v[160:175]
    v_cvt_pk_bf16_f32 v226, v140, v141
    v_cvt_pk_bf16_f32 v227, v142, v143
    v_mul_f32 v152, v152, v15
    v_mul_f32 v153, v153, v15
    v_mul_f32 v154, v154, v15
    v_mul_f32 v155, v155, v15
    v_mul_f32 v156, v156, v15
    s_add_u32 m0, s61, 16384
    s_nop 0
    buffer_load_dwordx4 v7, s[8:11], s59 offen lds
    s_add_u32 s59, s59, 8192
    s_add_u32 m0, s61, 17408
    s_nop 0
    buffer_load_dwordx4 v7, s[8:11], s59 offen lds
    s_add_u32 s59, s59, 8192
    v_mfma_f32_32x32x16_bf16 v[176:191], v[84:87], a[108:111], v[176:191]
    v_mul_f32 v157, v157, v15
    v_mul_f32 v158, v158, v15
    v_mul_f32 v159, v159, v15
    v_cvt_pk_bf16_f32 v228, v152, v153
    v_cvt_pk_bf16_f32 v229, v154, v155
    v_cvt_pk_bf16_f32 v230, v156, v157
    v_cvt_pk_bf16_f32 v231, v158, v159
    buffer_load_dwordx2 v[232:233], v11, s[20:23], 0 offen offset:0
    buffer_load_dwordx2 v[234:235], v11, s[20:23], 0 offen offset:16
    v_mfma_f32_32x32x16_bf16 a[128:143], v[192:195], v[224:227], a[128:143]
    buffer_load_dwordx2 v[236:237], v11, s[20:23], 0 offen offset:32
    buffer_load_dwordx2 v[238:239], v11, s[20:23], 0 offen offset:48
    v_mfma_f32_32x32x16_bf16 a[160:175], v[196:199], v[224:227], a[160:175]
    buffer_load_dwordx2 v[240:241], v13, s[28:31], 0 offen offset:0
    buffer_load_dwordx2 v[242:243], v13, s[28:31], 0 offen offset:16
    v_mfma_f32_32x32x16_bf16 a[144:159], v[192:195], v[228:231], a[144:159]
    buffer_load_dwordx2 v[244:245], v13, s[28:31], 0 offen offset:32
    buffer_load_dwordx2 v[246:247], v13, s[28:31], 0 offen offset:48
    v_mfma_f32_32x32x16_bf16 a[176:191], v[196:199], v[228:231], a[176:191]
    s_waitcnt vmcnt(32)
    s_waitcnt lgkmcnt(0)
    ds_read_b64_tr_b16 v[192:193], v8 offset:0
    ds_read_b64_tr_b16 v[194:195], v8 offset:1024
    ds_read_b64_tr_b16 v[196:197], v9 offset:0
    ds_read_b64_tr_b16 v[198:199], v9 offset:1024
    v_mfma_f32_32x32x16_bf16 v[128:143], v[88:91], a[0:3], 0
    v_add_f32 v14, s63, v168
    v_add_f32 v15, s63, v184
    v_rcp_f32 v14, v14
    v_rcp_f32 v15, v15
    v_mul_f32 v160, v160, v14
    v_mul_f32 v161, v161, v14
    v_mul_f32 v162, v162, v14
    v_mfma_f32_32x32x16_bf16 v[144:159], v[88:91], a[8:11], 0
    v_mul_f32 v163, v163, v14
    v_mul_f32 v164, v164, v14
    v_mul_f32 v165, v165, v14
    v_mul_f32 v166, v166, v14
    v_mul_f32 v167, v167, v14
    v_cvt_pk_bf16_f32 v224, v160, v161
    v_cvt_pk_bf16_f32 v225, v162, v163
    v_mfma_f32_32x32x16_bf16 v[128:143], v[92:95], a[4:7], v[128:143]
    v_cvt_pk_bf16_f32 v226, v164, v165
    v_cvt_pk_bf16_f32 v227, v166, v167
    v_mul_f32 v176, v176, v15
    v_mul_f32 v177, v177, v15
    v_mul_f32 v178, v178, v15
    v_mul_f32 v179, v179, v15
    v_mul_f32 v180, v180, v15
    v_mfma_f32_32x32x16_bf16 v[144:159], v[92:95], a[12:15], v[144:159]
    v_mul_f32 v181, v181, v15
    v_mul_f32 v182, v182, v15
    v_mul_f32 v183, v183, v15
    v_cvt_pk_bf16_f32 v228, v176, v177
    v_cvt_pk_bf16_f32 v229, v178, v179
    v_cvt_pk_bf16_f32 v230, v180, v181
    v_cvt_pk_bf16_f32 v231, v182, v183
    v_mfma_f32_32x32x16_bf16 a[128:143], v[208:211], v[224:227], a[128:143]
    v_mfma_f32_32x32x16_bf16 a[160:175], v[212:215], v[224:227], a[160:175]
    v_mfma_f32_32x32x16_bf16 a[144:159], v[208:211], v[228:231], a[144:159]
    v_mfma_f32_32x32x16_bf16 a[176:191], v[212:215], v[228:231], a[176:191]
    s_waitcnt vmcnt(26)
    s_waitcnt lgkmcnt(0)
    ds_read_b64_tr_b16 v[208:209], v8 offset:4096
    ds_read_b64_tr_b16 v[210:211], v8 offset:5120
    ds_read_b64_tr_b16 v[212:213], v9 offset:4096
    ds_read_b64_tr_b16 v[214:215], v9 offset:5120
    v_mfma_f32_32x32x16_bf16 v[160:175], v[96:99], a[16:19], 0
    v_add_f32 v14, s63, v128
    v_add_f32 v15, s63, v144
    v_rcp_f32 v14, v14
    v_rcp_f32 v15, v15
    v_mul_f32 v136, v136, v14
    v_mul_f32 v137, v137, v14
    v_mul_f32 v138, v138, v14
    v_mfma_f32_32x32x16_bf16 v[176:191], v[96:99], a[24:27], 0
    v_mul_f32 v139, v139, v14
    v_mul_f32 v140, v140, v14
    v_mul_f32 v141, v141, v14
    v_mul_f32 v142, v142, v14
    v_mul_f32 v143, v143, v14
    v_cvt_pk_bf16_f32 v224, v136, v137
    v_cvt_pk_bf16_f32 v225, v138, v139
    v_mfma_f32_32x32x16_bf16 v[160:175], v[100:103], a[20:23], v[160:175]
    v_cvt_pk_bf16_f32 v226, v140, v141
    v_cvt_pk_bf16_f32 v227, v142, v143
    v_mul_f32 v152, v152, v15
    v_mul_f32 v153, v153, v15
    v_mul_f32 v154, v154, v15
    v_mul_f32 v155, v155, v15
    v_mul_f32 v156, v156, v15
    v_mfma_f32_32x32x16_bf16 v[176:191], v[100:103], a[28:31], v[176:191]
    v_mul_f32 v157, v157, v15
    v_mul_f32 v158, v158, v15
    v_mul_f32 v159, v159, v15
    v_cvt_pk_bf16_f32 v228, v152, v153
    v_cvt_pk_bf16_f32 v229, v154, v155
    v_cvt_pk_bf16_f32 v230, v156, v157
    v_cvt_pk_bf16_f32 v231, v158, v159
    v_mfma_f32_32x32x16_bf16 a[128:143], v[192:195], v[224:227], a[128:143]
    v_mfma_f32_32x32x16_bf16 a[160:175], v[196:199], v[224:227], a[160:175]
    v_mfma_f32_32x32x16_bf16 a[144:159], v[192:195], v[228:231], a[144:159]
    v_mfma_f32_32x32x16_bf16 a[176:191], v[196:199], v[228:231], a[176:191]
    s_waitcnt vmcnt(20)
    s_waitcnt lgkmcnt(0)
    ds_read_b64_tr_b16 v[192:193], v8 offset:8192
    ds_read_b64_tr_b16 v[194:195], v8 offset:9216
    ds_read_b64_tr_b16 v[196:197], v9 offset:8192
    ds_read_b64_tr_b16 v[198:199], v9 offset:9216
    v_mfma_f32_32x32x16_bf16 v[128:143], v[104:107], a[32:35], 0
    v_add_f32 v14, s63, v168
    v_add_f32 v15, s63, v184
    v_rcp_f32 v14, v14
    v_rcp_f32 v15, v15
    v_mul_f32 v160, v160, v14
    v_mul_f32 v161, v161, v14
    v_mul_f32 v162, v162, v14
    v_mfma_f32_32x32x16_bf16 v[144:159], v[104:107], a[40:43], 0
    v_mul_f32 v163, v163, v14
    v_mul_f32 v164, v164, v14
    v_mul_f32 v165, v165, v14
    v_mul_f32 v166, v166, v14
    v_mul_f32 v167, v167, v14
    v_cvt_pk_bf16_f32 v224, v160, v161
    v_cvt_pk_bf16_f32 v225, v162, v163
    v_mfma_f32_32x32x16_bf16 v[128:143], v[108:111], a[36:39], v[128:143]
    v_cvt_pk_bf16_f32 v226, v164, v165
    v_cvt_pk_bf16_f32 v227, v166, v167
    v_mul_f32 v176, v176, v15
    v_mul_f32 v177, v177, v15
    v_mul_f32 v178, v178, v15
    v_mul_f32 v179, v179, v15
    v_mul_f32 v180, v180, v15
    v_mfma_f32_32x32x16_bf16 v[144:159], v[108:111], a[44:47], v[144:159]
    v_mul_f32 v181, v181, v15
    v_mul_f32 v182, v182, v15
    v_mul_f32 v183, v183, v15
    v_cvt_pk_bf16_f32 v228, v176, v177
    v_cvt_pk_bf16_f32 v229, v178, v179
    v_cvt_pk_bf16_f32 v230, v180, v181
    v_cvt_pk_bf16_f32 v231, v182, v183
    v_mfma_f32_32x32x16_bf16 a[128:143], v[208:211], v[224:227], a[128:143]
    v_mfma_f32_32x32x16_bf16 a[160:175], v[212:215], v[224:227], a[160:175]
    v_mfma_f32_32x32x16_bf16 a[144:159], v[208:211], v[228:231], a[144:159]
    v_mfma_f32_32x32x16_bf16 a[176:191], v[212:215], v[228:231], a[176:191]
    s_waitcnt vmcnt(14)
    s_waitcnt lgkmcnt(0)
    ds_read_b64_tr_b16 v[208:209], v8 offset:12288
    ds_read_b64_tr_b16 v[210:211], v8 offset:13312
    ds_read_b64_tr_b16 v[212:213], v9 offset:12288
    ds_read_b64_tr_b16 v[214:215], v9 offset:13312
    v_mfma_f32_32x32x16_bf16 v[160:175], v[112:115], a[48:51], 0
    v_add_f32 v14, s63, v128
    v_add_f32 v15, s63, v144
    v_rcp_f32 v14, v14
    v_rcp_f32 v15, v15
    v_mul_f32 v136, v136, v14
    v_mul_f32 v137, v137, v14
    v_mul_f32 v138, v138, v14
    v_mfma_f32_32x32x16_bf16 v[176:191], v[112:115], a[56:59], 0
    v_mul_f32 v139, v139, v14
    v_mul_f32 v140, v140, v14
    v_mul_f32 v141, v141, v14
    v_mul_f32 v142, v142, v14
    v_mul_f32 v143, v143, v14
    v_cvt_pk_bf16_f32 v224, v136, v137
    v_cvt_pk_bf16_f32 v225, v138, v139
    v_mfma_f32_32x32x16_bf16 v[160:175], v[116:119], a[52:55], v[160:175]
    v_cvt_pk_bf16_f32 v226, v140, v141
    v_cvt_pk_bf16_f32 v227, v142, v143
    v_mul_f32 v152, v152, v15
    v_mul_f32 v153, v153, v15
    v_mul_f32 v154, v154, v15
    v_mul_f32 v155, v155, v15
    v_mul_f32 v156, v156, v15
    v_mfma_f32_32x32x16_bf16 v[176:191], v[116:119], a[60:63], v[176:191]
    v_mul_f32 v157, v157, v15
    v_mul_f32 v158, v158, v15
    v_mul_f32 v159, v159, v15
    v_cvt_pk_bf16_f32 v228, v152, v153
    v_cvt_pk_bf16_f32 v229, v154, v155
    v_cvt_pk_bf16_f32 v230, v156, v157
    v_cvt_pk_bf16_f32 v231, v158, v159
    v_mfma_f32_32x32x16_bf16 a[128:143], v[192:195], v[224:227], a[128:143]
    v_mfma_f32_32x32x16_bf16 a[160:175], v[196:199], v[224:227], a[160:175]
    v_mfma_f32_32x32x16_bf16 a[144:159], v[192:195], v[228:231], a[144:159]
    v_mfma_f32_32x32x16_bf16 a[176:191], v[196:199], v[228:231], a[176:191]
    s_waitcnt vmcnt(8)
    s_waitcnt lgkmcnt(0)
    ds_read_b64_tr_b16 v[192:193], v8 offset:16384
    ds_read_b64_tr_b16 v[194:195], v8 offset:17408
    ds_read_b64_tr_b16 v[196:197], v9 offset:16384
    ds_read_b64_tr_b16 v[198:199], v9 offset:17408
    v_mfma_f32_32x32x16_bf16 v[128:143], v[120:123], a[64:67], 0
    v_add_f32 v14, s63, v168
    v_add_f32 v15, s63, v184
    v_rcp_f32 v14, v14
    v_rcp_f32 v15, v15
    v_mul_f32 v160, v160, v14
    v_mul_f32 v161, v161, v14
    v_mul_f32 v162, v162, v14
    v_mfma_f32_32x32x16_bf16 v[144:159], v[120:123], a[72:75], 0
    v_mul_f32 v163, v163, v14
    v_mul_f32 v164, v164, v14
    v_mul_f32 v165, v165, v14
    v_mul_f32 v166, v166, v14
    v_mul_f32 v167, v167, v14
    v_cvt_pk_bf16_f32 v224, v160, v161
    v_cvt_pk_bf16_f32 v225, v162, v163
    v_mfma_f32_32x32x16_bf16 v[128:143], v[124:127], a[68:71], v[128:143]
    v_cvt_pk_bf16_f32 v226, v164, v165
    v_cvt_pk_bf16_f32 v227, v166, v167
    v_mul_f32 v176, v176, v15
    v_mul_f32 v177, v177, v15
    v_mul_f32 v178, v178, v15
    v_mul_f32 v179, v179, v15
    v_mul_f32 v180, v180, v15
    v_mfma_f32_32x32x16_bf16 v[144:159], v[124:127], a[76:79], v[144:159]
    v_mul_f32 v181, v181, v15
    v_mul_f32 v182, v182, v15
    v_mul_f32 v183, v183, v15
    v_cvt_pk_bf16_f32 v228, v176, v177
    v_cvt_pk_bf16_f32 v229, v178, v179
    v_cvt_pk_bf16_f32 v230, v180, v181
    v_cvt_pk_bf16_f32 v231, v182, v183
    v_mfma_f32_32x32x16_bf16 a[128:143], v[208:211], v[224:227], a[128:143]
    v_mfma_f32_32x32x16_bf16 a[160:175], v[212:215], v[224:227], a[160:175]
    v_mfma_f32_32x32x16_bf16 a[144:159], v[208:211], v[228:231], a[144:159]
    v_mfma_f32_32x32x16_bf16 a[176:191], v[212:215], v[228:231], a[176:191]
    s_waitcnt lgkmcnt(0)
    v_add_f32 v14, s63, v128
    v_add_f32 v15, s63, v144
    v_rcp_f32 v14, v14
    v_rcp_f32 v15, v15
    v_mul_f32 v136, v136, v14
    v_mul_f32 v137, v137, v14
    v_mul_f32 v138, v138, v14
    v_mul_f32 v139, v139, v14
    v_mul_f32 v140, v140, v14
    v_mul_f32 v141, v141, v14
    v_mul_f32 v142, v142, v14
    v_mul_f32 v143, v143, v14
    v_cvt_pk_bf16_f32 v224, v136, v137
    v_cvt_pk_bf16_f32 v225, v138, v139
    v_cvt_pk_bf16_f32 v226, v140, v141
    v_cvt_pk_bf16_f32 v227, v142, v143
    v_mul_f32 v152, v152, v15
    v_mul_f32 v153, v153, v15
    v_mul_f32 v154, v154, v15
    v_mul_f32 v155, v155, v15
    v_mul_f32 v156, v156, v15
    v_mul_f32 v157, v157, v15
    v_mul_f32 v158, v158, v15
    v_mul_f32 v159, v159, v15
    v_cvt_pk_bf16_f32 v228, v152, v153
    v_cvt_pk_bf16_f32 v229, v154, v155
    v_cvt_pk_bf16_f32 v230, v156, v157
    v_cvt_pk_bf16_f32 v231, v158, v159
    v_mfma_f32_32x32x16_bf16 a[128:143], v[192:195], v[224:227], a[128:143]
    v_mfma_f32_32x32x16_bf16 a[160:175], v[196:199], v[224:227], a[160:175]
    v_mfma_f32_32x32x16_bf16 a[144:159], v[192:195], v[228:231], a[144:159]
    v_mfma_f32_32x32x16_bf16 a[176:191], v[196:199], v[228:231], a[176:191]
    v_add_u32 v14, s61, v2
    s_nop 9
    ds_write_b128 v14, a[144:147] offset:0
    ds_write_b128 v14, a[148:151] offset:1024
    ds_write_b128 v14, a[152:155] offset:2048
    ds_write_b128 v14, a[156:159] offset:3072
    ds_write_b128 v14, a[160:163] offset:4096
    ds_write_b128 v14, a[164:167] offset:5120
    ds_write_b128 v14, a[168:171] offset:6144
    ds_write_b128 v14, a[172:175] offset:7168
    ds_write_b128 v14, a[176:179] offset:8192
    ds_write_b128 v14, a[180:183] offset:9216
    ds_write_b128 v14, a[184:187] offset:10240
    ds_write_b128 v14, a[188:191] offset:11264
    s_xor_b32 s55, s50, 1
    s_mul_i32 s55, s55, 28672
    v_add_u32 v15, s55, v2
    s_xor_b32 s55, s50, 2
    s_mul_i32 s55, s55, 28672
    v_add_u32 v16, s55, v2
    s_xor_b32 s55, s50, 3
    s_mul_i32 s55, s55, 28672
    v_add_u32 v17, s55, v2
    v_accvgpr_read_b32 v64, a128
    v_accvgpr_read_b32 v65, a129
    v_accvgpr_read_b32 v66, a130
    v_accvgpr_read_b32 v67, a131
    v_accvgpr_read_b32 v68, a132
    v_accvgpr_read_b32 v69, a133
    v_accvgpr_read_b32 v70, a134
    v_accvgpr_read_b32 v71, a135
    v_accvgpr_read_b32 v72, a136
    v_accvgpr_read_b32 v73, a137
    v_accvgpr_read_b32 v74, a138
    v_accvgpr_read_b32 v75, a139
    v_accvgpr_read_b32 v76, a140
    v_accvgpr_read_b32 v77, a141
    v_accvgpr_read_b32 v78, a142
    v_accvgpr_read_b32 v79, a143
    s_waitcnt vmcnt(0)
    v_lshlrev_b32 v18, 16, v232
    v_and_b32 v19, 0xffff0000, v232
    v_lshlrev_b32 v20, 16, v240
    v_and_b32 v21, 0xffff0000, v240
    v_add_f32 v18, v18, v20
    v_add_f32 v19, v19, v21
    v_add_f32 v64, v64, v18
    v_add_f32 v65, v65, v19
    v_lshlrev_b32 v18, 16, v233
    v_and_b32 v19, 0xffff0000, v233
    v_lshlrev_b32 v20, 16, v241
    v_and_b32 v21, 0xffff0000, v241
    v_add_f32 v18, v18, v20
    v_add_f32 v19, v19, v21
    v_add_f32 v66, v66, v18
    v_add_f32 v67, v67, v19
    v_lshlrev_b32 v18, 16, v234
    v_and_b32 v19, 0xffff0000, v234
    v_lshlrev_b32 v20, 16, v242
    v_and_b32 v21, 0xffff0000, v242
    v_add_f32 v18, v18, v20
    v_add_f32 v19, v19, v21
    v_add_f32 v68, v68, v18
    v_add_f32 v69, v69, v19
    v_lshlrev_b32 v18, 16, v235
    v_and_b32 v19, 0xffff0000, v235
    v_lshlrev_b32 v20, 16, v243
    v_and_b32 v21, 0xffff0000, v243
    v_add_f32 v18, v18, v20
    v_add_f32 v19, v19, v21
    v_add_f32 v70, v70, v18
    v_add_f32 v71, v71, v19
    v_lshlrev_b32 v18, 16, v236
    v_and_b32 v19, 0xffff0000, v236
    v_lshlrev_b32 v20, 16, v244
    v_and_b32 v21, 0xffff0000, v244
    v_add_f32 v18, v18, v20
    v_add_f32 v19, v19, v21
    v_add_f32 v72, v72, v18
    v_add_f32 v73, v73, v19
    v_lshlrev_b32 v18, 16, v237
    v_and_b32 v19, 0xffff0000, v237
    v_lshlrev_b32 v20, 16, v245
    v_and_b32 v21, 0xffff0000, v245
    v_add_f32 v18, v18, v20
    v_add_f32 v19, v19, v21
    v_add_f32 v74, v74, v18
    v_add_f32 v75, v75, v19
    v_lshlrev_b32 v18, 16, v238
    v_and_b32 v19, 0xffff0000, v238
    v_lshlrev_b32 v20, 16, v246
    v_and_b32 v21, 0xffff0000, v246
    v_add_f32 v18, v18, v20
    v_add_f32 v19, v19, v21
    v_add_f32 v76, v76, v18
    v_add_f32 v77, v77, v19
    v_lshlrev_b32 v18, 16, v239
    v_and_b32 v19, 0xffff0000, v239
    v_lshlrev_b32 v20, 16, v247
    v_and_b32 v21, 0xffff0000, v247
    v_add_f32 v18, v18, v20
    v_add_f32 v19, v19, v21
    v_add_f32 v78, v78, v18
    v_add_f32 v79, v79, v19
    s_waitcnt lgkmcnt(0)
    s_barrier
    ds_read_b128 v[128:131], v15 offset:0
    ds_read_b128 v[132:135], v15 offset:1024
    ds_read_b128 v[136:139], v15 offset:2048
    ds_read_b128 v[140:143], v15 offset:3072
    ds_read_b128 v[144:147], v16 offset:4096
    ds_read_b128 v[148:151], v16 offset:5120
    ds_read_b128 v[152:155], v16 offset:6144
    ds_read_b128 v[156:159], v16 offset:7168
    ds_read_b128 v[160:163], v17 offset:8192
    ds_read_b128 v[164:167], v17 offset:9216
    ds_read_b128 v[168:171], v17 offset:10240
    ds_read_b128 v[172:175], v17 offset:11264
    v_lshl_add_u32 v11, v12, 3, v11
    s_waitcnt lgkmcnt(8)
    v_add_f32 v64, v64, v128
    v_add_f32 v65, v65, v129
    v_add_f32 v66, v66, v130
    v_add_f32 v67, v67, v131
    v_add_f32 v68, v68, v132
    v_add_f32 v69, v69, v133
    v_add_f32 v70, v70, v134
    v_add_f32 v71, v71, v135
    v_add_f32 v72, v72, v136
    v_add_f32 v73, v73, v137
    v_add_f32 v74, v74, v138
    v_add_f32 v75, v75, v139
    v_add_f32 v76, v76, v140
    v_add_f32 v77, v77, v141
    v_add_f32 v78, v78, v142
    v_add_f32 v79, v79, v143
    s_waitcnt lgkmcnt(4)
    v_add_f32 v64, v64, v144
    v_add_f32 v65, v65, v145
    v_add_f32 v66, v66, v146
    v_add_f32 v67, v67, v147
    v_add_f32 v68, v68, v148
    v_add_f32 v69, v69, v149
    v_add_f32 v70, v70, v150
    v_add_f32 v71, v71, v151
    v_add_f32 v72, v72, v152
    v_add_f32 v73, v73, v153
    v_add_f32 v74, v74, v154
    v_add_f32 v75, v75, v155
    v_add_f32 v76, v76, v156
    v_add_f32 v77, v77, v157
    v_add_f32 v78, v78, v158
    v_add_f32 v79, v79, v159
    s_waitcnt lgkmcnt(0)
    v_add_f32 v64, v64, v160
    v_add_f32 v65, v65, v161
    v_add_f32 v66, v66, v162
    v_add_f32 v67, v67, v163
    v_add_f32 v68, v68, v164
    v_add_f32 v69, v69, v165
    v_add_f32 v70, v70, v166
    v_add_f32 v71, v71, v167
    v_add_f32 v72, v72, v168
    v_add_f32 v73, v73, v169
    v_add_f32 v74, v74, v170
    v_add_f32 v75, v75, v171
    v_add_f32 v76, v76, v172
    v_add_f32 v77, v77, v173
    v_add_f32 v78, v78, v174
    v_add_f32 v79, v79, v175
    v_cvt_pk_bf16_f32 v80, v64, v65
    v_cvt_pk_bf16_f32 v81, v66, v67
    v_cvt_pk_bf16_f32 v82, v68, v69
    v_cvt_pk_bf16_f32 v83, v70, v71
    v_cvt_pk_bf16_f32 v84, v72, v73
    v_cvt_pk_bf16_f32 v85, v74, v75
    v_cvt_pk_bf16_f32 v86, v76, v77
    v_cvt_pk_bf16_f32 v87, v78, v79
s_nop 1
    v_permlane32_swap_b32 v80, v82
s_nop 1
    v_permlane32_swap_b32 v81, v83
s_nop 1
    v_permlane32_swap_b32 v84, v86
s_nop 1
    v_permlane32_swap_b32 v85, v87
    buffer_store_dwordx4 v[80:83], v11, s[24:27], 0 offen offset:0
    buffer_store_dwordx4 v[84:87], v11, s[24:27], 0 offen offset:32
K2_END:
    s_endpgm
.section .rodata,"a"
.p2align 6
.amdhsa_kernel k1_kernel
  .amdhsa_next_free_vgpr 240
  .amdhsa_next_free_sgpr 96
  .amdhsa_accum_offset 240
  .amdhsa_group_segment_fixed_size 0
  .amdhsa_kernarg_size 96
  .amdhsa_user_sgpr_count 2
  .amdhsa_user_sgpr_kernarg_segment_ptr 1
  .amdhsa_system_sgpr_workgroup_id_x 1
.end_amdhsa_kernel
.p2align 6
.amdhsa_kernel k2_kernel
  .amdhsa_next_free_vgpr 448
  .amdhsa_next_free_sgpr 96
  .amdhsa_accum_offset 256
  .amdhsa_group_segment_fixed_size 0
  .amdhsa_kernarg_size 96
  .amdhsa_user_sgpr_count 2
  .amdhsa_user_sgpr_kernarg_segment_ptr 1
  .amdhsa_system_sgpr_workgroup_id_x 1
.end_amdhsa_kernel
```
